```python
import torch

def _softmax(x, axis=-1):
    return torch.softmax(x, dim=axis)
def _gelu(x):
    return torch.nn.functional.gelu(x, approximate="tanh")
def _silu(x):
    return torch.nn.functional.silu(x)
def _sigmoid(x):
    return torch.sigmoid(x)
def _layernorm(x, axis=-1, eps=1e-5):
    m = x.mean(dim=axis, keepdim=True)
    v = x.var(dim=axis, keepdim=True, unbiased=False)
    return (x - m) / torch.sqrt(v + eps)
def _scatter_add(tgt, idx, src, axis=0):
    return tgt.clone().index_add_(axis, idx, src)
def _segment_sum(src, seg, n):
    out = torch.zeros((n,) + src.shape[1:], dtype=src.dtype)
    return out.index_add_(0, seg, src)
def _pad(x, pw):
    flat = tuple(v for pair in reversed(pw) for v in pair)
    return torch.nn.functional.pad(x, flat)

kernel_name = 'standalone__gqa_block_cached__sampling'

def setup_inputs():

    _w = (lambda a: (lambda t: t.to(torch.bfloat16) if t.is_floating_point() else t)(torch.as_tensor(a)))
    B, Sq, D = 16, 1, 576
    Hq, Hkv, Sk, Dh = 32, 16, 4096, 128
    assert Hq % Hkv == 0, (Hq, Hkv)
    return {
        "x": _w((lambda *s: torch.randn(*s, dtype=torch.bfloat16) * 0.8)(B, Sq, D)),
        "k_cache": _w((lambda *s: torch.randn(*s, dtype=torch.bfloat16) * 0.8)(B, Hkv, Sk, Dh)),
        "v_cache": _w((lambda *s: torch.randn(*s, dtype=torch.bfloat16) * 0.05)(B, Hkv, Sk, Dh)),
        "wq": _w((lambda *s: torch.randn(*s, dtype=torch.bfloat16) * 0.8)(D, Hq * Dh) * (D ** -0.5)),
        "wo": _w((lambda *s: torch.randn(*s, dtype=torch.bfloat16) * 0.05)(Hq * Dh, D) * ((Hq * Dh) ** -0.5)),
    }

def reference(x, k_cache, v_cache, wq, wo):
    B, Sq, D = x.shape
    Hq, Dh = 32, 128
    Hkv = k_cache.shape[1]
    rep = Hq // Hkv
    q = (lambda x, *d: x.permute(*d))((x @ wq).reshape(B, Sq, Hq, Dh), 0, 2, 1, 3)
    k = (lambda x, n, axis: torch.repeat_interleave(x, n, dim=axis))(k_cache, rep, axis=1)
    v = (lambda x, n, axis: torch.repeat_interleave(x, n, dim=axis))(v_cache, rep, axis=1)
    scores = torch.einsum("bhqd,bhkd->bhqk", q, k) * (Dh ** -0.5)
    p = _softmax(scores, axis=-1)
    o = torch.einsum("bhqk,bhkd->bhqd", p, v)
    return (lambda x, *d: x.permute(*d))(o, 0, 2, 1, 3).reshape(B, Sq, Hq * Dh) @ wo
```

```asm
; @launch grid=(256,1,1) block=(512,1,1) lds=146016
.amdgcn_target "amdgcn-amd-amdhsa--gfx950"
.text
.globl standalone__gqa_block_cached__sampling_kernel
.p2align 8
.type standalone__gqa_block_cached__sampling_kernel,@function
standalone__gqa_block_cached__sampling_kernel:
    s_cmp_ge_u32 s2, 256
    s_cbranch_scc1 L_end
    s_load_dwordx16 s[4:19], s[0:1], 0
    v_lshrrev_b32 v2, 6, v0
    v_and_b32 v1, 63, v0
    v_readfirstlane_b32 s3, v2
    s_and_b32 s48, s2, 15
    s_lshr_b32 s49, s2, 4
    s_cmp_ge_u32 s3, 4
    s_cbranch_scc0 L_stream
L_aux:
    s_sub_u32 s61, s3, 4
    s_mul_i32 s62, s48, 294912
    s_mov_b32 s34, 294912
    s_mov_b32 s35, 0x20000
    s_lshl_b32 s63, s49, 2
    s_add_u32 s63, s63, 983040
    s_cmp_eq_u32 s61, 0
    s_cbranch_scc1 L_qwave
    s_waitcnt lgkmcnt(0)
    s_load_dword s60, s[18:19], s63
    s_add_u32 s32, s12, s62
    s_addc_u32 s33, s13, 0
    s_and_b32 s33, s33, 0xffff
    s_cmp_lg_u32 s61, 1
    s_cbranch_scc1 L_nowarm
    s_mul_i32 s55, s49, 18432
    v_lshlrev_b32 v3, 4, v1
    buffer_load_dwordx4 v[40:43], v3, s[32:35], s55 offen offset:0
    buffer_load_dwordx4 v[40:43], v3, s[32:35], s55 offen offset:1024
    buffer_load_dwordx4 v[40:43], v3, s[32:35], s55 offen offset:2048
    buffer_load_dwordx4 v[40:43], v3, s[32:35], s55 offen offset:3072
    s_add_u32 s55, s55, 0x1000
    buffer_load_dwordx4 v[40:43], v3, s[32:35], s55 offen offset:0
    buffer_load_dwordx4 v[40:43], v3, s[32:35], s55 offen offset:1024
    buffer_load_dwordx4 v[40:43], v3, s[32:35], s55 offen offset:2048
    buffer_load_dwordx4 v[40:43], v3, s[32:35], s55 offen offset:3072
    s_add_u32 s55, s55, 0x1000
    buffer_load_dwordx4 v[40:43], v3, s[32:35], s55 offen offset:0
    buffer_load_dwordx4 v[40:43], v3, s[32:35], s55 offen offset:1024
    buffer_load_dwordx4 v[40:43], v3, s[32:35], s55 offen offset:2048
    buffer_load_dwordx4 v[40:43], v3, s[32:35], s55 offen offset:3072
    s_add_u32 s55, s55, 0x1000
    buffer_load_dwordx4 v[40:43], v3, s[32:35], s55 offen offset:0
    buffer_load_dwordx4 v[40:43], v3, s[32:35], s55 offen offset:1024
    buffer_load_dwordx4 v[40:43], v3, s[32:35], s55 offen offset:2048
    buffer_load_dwordx4 v[40:43], v3, s[32:35], s55 offen offset:3072
    s_add_u32 s55, s55, 0x1000
    buffer_load_dwordx4 v[40:43], v3, s[32:35], s55 offen offset:0
    buffer_load_dwordx4 v[40:43], v3, s[32:35], s55 offen offset:1024
    s_waitcnt vmcnt(0)
L_nowarm:
    s_barrier
    s_branch L_qdone
L_qwave:
    s_setprio 2
    v_and_b32 v3, 15, v1
    v_lshrrev_b32 v8, 4, v1
    v_mul_u32_u24 v10, 1152, v3
    v_mad_u32_u24 v10, v8, 36, v10
    v_mad_u32_u24 v10, v8, 36, v10
    v_mul_u32_u24 v11, 294912, v8
    v_lshl_add_u32 v11, v3, 3, v11
    v_lshlrev_b32 v12, 14, v8
    v_lshl_add_u32 v12, v3, 4, v12
    v_add_u32 v15, 0x9e3779b9, v3
    s_lshl_b32 s51, s48, 9
    s_mov_b32 s38, 18432
    s_mov_b32 s39, 0x20000
    s_sub_u32 s30, 4718592, s51
    s_mov_b32 s31, 0x20000
    s_lshl_b32 s52, s48, 16
    s_add_u32 s52, s52, 1048576
    s_mov_b32 s46, 0x10000
    s_mov_b32 s47, 0x20000
    s_mov_b32 s53, s49
    s_mov_b32 s54, 0
    s_mov_b32 s56, 0x05040100
    s_mov_b32 s57, 0x07060302
    s_waitcnt lgkmcnt(0)
    s_add_u32 s28, s10, s51
    s_addc_u32 s29, s11, 0
    s_and_b32 s29, s29, 0xffff
    s_mov_b32 s36, s4
    s_and_b32 s37, s5, 0xffff
    s_add_u32 s44, s18, s52
    s_addc_u32 s45, s19, 0
    s_and_b32 s45, s45, 0xffff
    s_add_u32 s32, s12, s62
    s_addc_u32 s33, s13, 0
    s_and_b32 s33, s33, 0xffff
    s_load_dword s60, s[18:19], s63
L_produce:
    s_lshr_b32 s58, s53, 2
    s_and_b32 s59, s53, 3
    s_mul_i32 s50, s59, 1179648
    s_lshl_b32 s55, s58, 7
    s_add_u32 s50, s50, s55
    s_mul_i32 s55, s59, 288
    buffer_load_dwordx2 v[72:73], v11, s[28:31], s50 offen
    s_add_u32 s50, s50, 0x2000
    buffer_load_dwordx2 v[74:75], v11, s[28:31], s50 offen
    s_add_u32 s50, s50, 0x2000
    buffer_load_dwordx2 v[76:77], v11, s[28:31], s50 offen
    s_add_u32 s50, s50, 0x2000
    buffer_load_dwordx2 v[78:79], v11, s[28:31], s50 offen
    s_add_u32 s50, s50, 0x2000
    buffer_load_dwordx2 v[80:81], v11, s[28:31], s50 offen
    s_add_u32 s50, s50, 0x2000
    buffer_load_dwordx2 v[82:83], v11, s[28:31], s50 offen
    s_add_u32 s50, s50, 0x2000
    buffer_load_dwordx2 v[84:85], v11, s[28:31], s50 offen
    s_add_u32 s50, s50, 0x2000
    buffer_load_dwordx2 v[86:87], v11, s[28:31], s50 offen
    s_add_u32 s50, s50, 0x2000
    buffer_load_dwordx4 v[48:51], v10, s[36:39], s55 offen offset:0
    buffer_load_dwordx4 v[52:55], v10, s[36:39], s55 offen offset:16
    buffer_load_dwordx4 v[56:59], v10, s[36:39], s55 offen offset:32
    buffer_load_dwordx4 v[60:63], v10, s[36:39], s55 offen offset:48
    buffer_load_dwordx2 v[64:65], v10, s[36:39], s55 offen offset:64
    buffer_load_dwordx2 v[88:89], v11, s[28:31], s50 offen
    s_add_u32 s50, s50, 0x2000
    buffer_load_dwordx2 v[90:91], v11, s[28:31], s50 offen
    s_add_u32 s50, s50, 0x2000
    buffer_load_dwordx2 v[92:93], v11, s[28:31], s50 offen
    s_add_u32 s50, s50, 0x2000
    buffer_load_dwordx2 v[94:95], v11, s[28:31], s50 offen
    s_add_u32 s50, s50, 0x2000
    buffer_load_dwordx2 v[96:97], v11, s[28:31], s50 offen
    s_add_u32 s50, s50, 0x2000
    buffer_load_dwordx2 v[98:99], v11, s[28:31], s50 offen
    s_add_u32 s50, s50, 0x2000
    buffer_load_dwordx2 v[100:101], v11, s[28:31], s50 offen
    s_add_u32 s50, s50, 0x2000
    buffer_load_dwordx2 v[102:103], v11, s[28:31], s50 offen
    s_add_u32 s50, s50, 0x2000
    buffer_load_dwordx2 v[104:105], v11, s[28:31], s50 offen
    s_add_u32 s50, s50, 0x2000
    buffer_load_dwordx2 v[106:107], v11, s[28:31], s50 offen
    s_add_u32 s50, s50, 0x2000
    buffer_load_dwordx2 v[108:109], v11, s[28:31], s50 offen
    s_add_u32 s50, s50, 0x2000
    buffer_load_dwordx2 v[110:111], v11, s[28:31], s50 offen
    s_add_u32 s50, s50, 0x2000
    buffer_load_dwordx2 v[112:113], v11, s[28:31], s50 offen
    s_add_u32 s50, s50, 0x2000
    buffer_load_dwordx2 v[114:115], v11, s[28:31], s50 offen
    s_add_u32 s50, s50, 0x2000
    buffer_load_dwordx2 v[116:117], v11, s[28:31], s50 offen
    s_add_u32 s50, s50, 0x2000
    buffer_load_dwordx2 v[118:119], v11, s[28:31], s50 offen
    s_add_u32 s50, s50, 0x2000
    buffer_load_dwordx2 v[120:121], v11, s[28:31], s50 offen
    s_add_u32 s50, s50, 0x2000
    buffer_load_dwordx2 v[122:123], v11, s[28:31], s50 offen
    s_add_u32 s50, s50, 0x2000
    buffer_load_dwordx2 v[124:125], v11, s[28:31], s50 offen
    s_add_u32 s50, s50, 0x2000
    buffer_load_dwordx2 v[126:127], v11, s[28:31], s50 offen
    s_add_u32 s50, s50, 0x2000
    buffer_load_dwordx2 v[128:129], v11, s[28:31], s50 offen
    s_add_u32 s50, s50, 0x2000
    buffer_load_dwordx2 v[130:131], v11, s[28:31], s50 offen
    s_add_u32 s50, s50, 0x2000
    buffer_load_dwordx2 v[132:133], v11, s[28:31], s50 offen
    s_add_u32 s50, s50, 0x2000
    buffer_load_dwordx2 v[134:135], v11, s[28:31], s50 offen
    s_add_u32 s50, s50, 0x2000
    buffer_load_dwordx2 v[136:137], v11, s[28:31], s50 offen
    s_add_u32 s50, s50, 0x2000
    buffer_load_dwordx2 v[138:139], v11, s[28:31], s50 offen
    s_add_u32 s50, s50, 0x2000
    buffer_load_dwordx2 v[140:141], v11, s[28:31], s50 offen
    s_add_u32 s50, s50, 0x2000
    buffer_load_dwordx2 v[142:143], v11, s[28:31], s50 offen
    v_and_b32 v13, 0x30, v1
    v_add_u32 v13, 983040, v13
    global_load_dwordx4 v[16:19], v13, s[18:19]
    s_lshl_b32 s50, s59, 10
    s_lshl_b32 s55, s58, 8
    s_add_u32 s50, s50, s55
    s_waitcnt vmcnt(29)
    v_perm_b32 v148, v74, v72, s56
    v_perm_b32 v149, v78, v76, s56
    v_perm_b32 v150, v82, v80, s56
    v_perm_b32 v151, v86, v84, s56
    v_perm_b32 v166, v74, v72, s57
    v_perm_b32 v167, v78, v76, s57
    v_perm_b32 v168, v82, v80, s57
    v_perm_b32 v169, v86, v84, s57
    v_perm_b32 v184, v75, v73, s56
    v_perm_b32 v185, v79, v77, s56
    v_perm_b32 v186, v83, v81, s56
    v_perm_b32 v187, v87, v85, s56
    v_perm_b32 v202, v75, v73, s57
    v_perm_b32 v203, v79, v77, s57
    v_perm_b32 v204, v83, v81, s57
    v_perm_b32 v205, v87, v85, s57
    s_nop 1
    v_mfma_f32_16x16x32_bf16 v[224:227], v[48:51], v[148:151], 0
    v_mfma_f32_16x16x32_bf16 v[228:231], v[48:51], v[166:169], 0
    v_mfma_f32_16x16x32_bf16 v[232:235], v[48:51], v[184:187], 0
    v_mfma_f32_16x16x32_bf16 v[236:239], v[48:51], v[202:205], 0
    s_waitcnt vmcnt(21)
    v_perm_b32 v152, v90, v88, s56
    v_perm_b32 v153, v94, v92, s56
    v_perm_b32 v154, v98, v96, s56
    v_perm_b32 v155, v102, v100, s56
    v_perm_b32 v170, v90, v88, s57
    v_perm_b32 v171, v94, v92, s57
    v_perm_b32 v172, v98, v96, s57
    v_perm_b32 v173, v102, v100, s57
    v_perm_b32 v188, v91, v89, s56
    v_perm_b32 v189, v95, v93, s56
    v_perm_b32 v190, v99, v97, s56
    v_perm_b32 v191, v103, v101, s56
    v_perm_b32 v206, v91, v89, s57
    v_perm_b32 v207, v95, v93, s57
    v_perm_b32 v208, v99, v97, s57
    v_perm_b32 v209, v103, v101, s57
    s_nop 1
    v_mfma_f32_16x16x32_bf16 v[224:227], v[52:55], v[152:155], v[224:227]
    v_mfma_f32_16x16x32_bf16 v[228:231], v[52:55], v[170:173], v[228:231]
    v_mfma_f32_16x16x32_bf16 v[232:235], v[52:55], v[188:191], v[232:235]
    v_mfma_f32_16x16x32_bf16 v[236:239], v[52:55], v[206:209], v[236:239]
    s_waitcnt vmcnt(13)
    v_perm_b32 v156, v106, v104, s56
    v_perm_b32 v157, v110, v108, s56
    v_perm_b32 v158, v114, v112, s56
    v_perm_b32 v159, v118, v116, s56
    v_perm_b32 v174, v106, v104, s57
    v_perm_b32 v175, v110, v108, s57
    v_perm_b32 v176, v114, v112, s57
    v_perm_b32 v177, v118, v116, s57
    v_perm_b32 v192, v107, v105, s56
    v_perm_b32 v193, v111, v109, s56
    v_perm_b32 v194, v115, v113, s56
    v_perm_b32 v195, v119, v117, s56
    v_perm_b32 v210, v107, v105, s57
    v_perm_b32 v211, v111, v109, s57
    v_perm_b32 v212, v115, v113, s57
    v_perm_b32 v213, v119, v117, s57
    s_nop 1
    v_mfma_f32_16x16x32_bf16 v[224:227], v[56:59], v[156:159], v[224:227]
    v_mfma_f32_16x16x32_bf16 v[228:231], v[56:59], v[174:177], v[228:231]
    v_mfma_f32_16x16x32_bf16 v[232:235], v[56:59], v[192:195], v[232:235]
    v_mfma_f32_16x16x32_bf16 v[236:239], v[56:59], v[210:213], v[236:239]
    s_waitcnt vmcnt(5)
    v_perm_b32 v160, v122, v120, s56
    v_perm_b32 v161, v126, v124, s56
    v_perm_b32 v162, v130, v128, s56
    v_perm_b32 v163, v134, v132, s56
    v_perm_b32 v178, v122, v120, s57
    v_perm_b32 v179, v126, v124, s57
    v_perm_b32 v180, v130, v128, s57
    v_perm_b32 v181, v134, v132, s57
    v_perm_b32 v196, v123, v121, s56
    v_perm_b32 v197, v127, v125, s56
    v_perm_b32 v198, v131, v129, s56
    v_perm_b32 v199, v135, v133, s56
    v_perm_b32 v214, v123, v121, s57
    v_perm_b32 v215, v127, v125, s57
    v_perm_b32 v216, v131, v129, s57
    v_perm_b32 v217, v135, v133, s57
    s_nop 1
    v_mfma_f32_16x16x32_bf16 v[224:227], v[60:63], v[160:163], v[224:227]
    v_mfma_f32_16x16x32_bf16 v[228:231], v[60:63], v[178:181], v[228:231]
    v_mfma_f32_16x16x32_bf16 v[232:235], v[60:63], v[196:199], v[232:235]
    v_mfma_f32_16x16x32_bf16 v[236:239], v[60:63], v[214:217], v[236:239]
    s_waitcnt vmcnt(0)
    v_perm_b32 v164, v138, v136, s56
    v_perm_b32 v165, v142, v140, s56
    v_perm_b32 v182, v138, v136, s57
    v_perm_b32 v183, v142, v140, s57
    v_perm_b32 v200, v139, v137, s56
    v_perm_b32 v201, v143, v141, s56
    v_perm_b32 v218, v139, v137, s57
    v_perm_b32 v219, v143, v141, s57
    s_nop 1
    v_mfma_f32_16x16x16_bf16 v[224:227], v[64:65], v[164:165], v[224:227]
    v_mfma_f32_16x16x16_bf16 v[228:231], v[64:65], v[182:183], v[228:231]
    v_mfma_f32_16x16x16_bf16 v[232:235], v[64:65], v[200:201], v[232:235]
    v_mfma_f32_16x16x16_bf16 v[236:239], v[64:65], v[218:219], v[236:239]
    s_waitcnt lgkmcnt(0)
    v_add_u32 v36, s60, v15
    v_lshrrev_b32 v37, 4, v36
    v_lshrrev_b32 v38, 8, v36
    v_lshrrev_b32 v39, 12, v36
    s_nop 3
    v_bfi_b32 v240, 15, v36, v224
    v_bfi_b32 v241, 15, v37, v228
    v_bfi_b32 v242, 15, v38, v232
    v_bfi_b32 v243, 15, v39, v236
    buffer_store_dwordx4 v[240:243], v12, s[44:47], s50 offen
    s_add_u32 s50, s50, 0x1000
    v_bfi_b32 v244, 15, v36, v225
    v_bfi_b32 v245, 15, v37, v229
    v_bfi_b32 v246, 15, v38, v233
    v_bfi_b32 v247, 15, v39, v237
    buffer_store_dwordx4 v[244:247], v12, s[44:47], s50 offen
    s_add_u32 s50, s50, 0x1000
    v_bfi_b32 v248, 15, v36, v226
    v_bfi_b32 v249, 15, v37, v230
    v_bfi_b32 v250, 15, v38, v234
    v_bfi_b32 v251, 15, v39, v238
    buffer_store_dwordx4 v[248:251], v12, s[44:47], s50 offen
    s_add_u32 s50, s50, 0x1000
    v_bfi_b32 v252, 15, v36, v227
    v_bfi_b32 v253, 15, v37, v231
    v_bfi_b32 v254, 15, v38, v235
    v_bfi_b32 v255, 15, v39, v239
    buffer_store_dwordx4 v[252:255], v12, s[44:47], s50 offen
    s_cmp_eq_u32 s54, 0
    s_cbranch_scc1 L_first
    s_waitcnt vmcnt(0)
    s_add_u32 s53, s53, 1
    s_cmp_lt_u32 s53, 16
    s_cbranch_scc1 L_produce
    s_branch L_consume
L_first:
    v_lshlrev_b32 v3, 4, v1
    v_add_u32 v20, v15, v16
    v_lshrrev_b32 v21, 4, v20
    v_lshrrev_b32 v22, 8, v20
    v_lshrrev_b32 v23, 12, v20
    v_add_u32 v24, v15, v17
    v_lshrrev_b32 v25, 4, v24
    v_lshrrev_b32 v26, 8, v24
    v_lshrrev_b32 v27, 12, v24
    v_add_u32 v28, v15, v18
    v_lshrrev_b32 v29, 4, v28
    v_lshrrev_b32 v30, 8, v28
    v_lshrrev_b32 v31, 12, v28
    v_add_u32 v32, v15, v19
    v_lshrrev_b32 v33, 4, v32
    v_lshrrev_b32 v34, 8, v32
    v_lshrrev_b32 v35, 12, v32
    s_barrier
L_consume:
    s_lshl_b32 s50, s49, 12
    s_mov_b32 s58, 200
L_qpoll:
    buffer_load_dwordx4 v[48:51], v3, s[44:47], s50 offen offset:0 sc1
    buffer_load_dwordx4 v[52:55], v3, s[44:47], s50 offen offset:1024 sc1
    buffer_load_dwordx4 v[56:59], v3, s[44:47], s50 offen offset:2048 sc1
    buffer_load_dwordx4 v[60:63], v3, s[44:47], s50 offen offset:3072 sc1
    s_waitcnt vmcnt(0)
    v_xor_b32 v72, v20, v48
    v_xor_b32 v73, v21, v49
    v_xor_b32 v74, v22, v50
    v_xor_b32 v75, v23, v51
    v_xor_b32 v76, v24, v52
    v_xor_b32 v77, v25, v53
    v_xor_b32 v78, v26, v54
    v_xor_b32 v79, v27, v55
    v_xor_b32 v80, v28, v56
    v_xor_b32 v81, v29, v57
    v_xor_b32 v82, v30, v58
    v_xor_b32 v83, v31, v59
    v_xor_b32 v84, v32, v60
    v_xor_b32 v85, v33, v61
    v_xor_b32 v86, v34, v62
    v_xor_b32 v87, v35, v63
    v_or3_b32 v72, v72, v73, v74
    v_or3_b32 v72, v72, v75, v76
    v_or3_b32 v72, v72, v77, v78
    v_or3_b32 v72, v72, v79, v80
    v_or3_b32 v72, v72, v81, v82
    v_or3_b32 v72, v72, v83, v84
    v_or3_b32 v72, v72, v85, v86
    v_or_b32 v72, v72, v87
    v_and_b32 v72, 15, v72
    v_cmp_ne_u32 vcc, 0, v72
    s_nop 4
    s_cbranch_vccz L_qready
    s_cmp_lg_u32 s54, 0
    s_cbranch_scc1 L_qready
    s_sub_u32 s58, s58, 1
    s_cbranch_scc0 L_qpoll
    s_mov_b32 s54, 1
    s_mov_b32 s53, 0
    s_lshl_b32 s52, s2, 16
    s_add_u32 s52, s52, 16777216
    s_add_u32 s44, s18, s52
    s_addc_u32 s45, s19, 0
    s_and_b32 s45, s45, 0xffff
    s_branch L_produce
L_qready:
    v_bfi_b32 v48, 15, 8, v48
    v_bfi_b32 v49, 15, 8, v49
    v_bfi_b32 v50, 15, 8, v50
    v_bfi_b32 v51, 15, 8, v51
    v_bfi_b32 v52, 15, 8, v52
    v_bfi_b32 v53, 15, 8, v53
    v_bfi_b32 v54, 15, 8, v54
    v_bfi_b32 v55, 15, 8, v55
    v_bfi_b32 v56, 15, 8, v56
    v_bfi_b32 v57, 15, 8, v57
    v_bfi_b32 v58, 15, 8, v58
    v_bfi_b32 v59, 15, 8, v59
    v_bfi_b32 v60, 15, 8, v60
    v_bfi_b32 v61, 15, 8, v61
    v_bfi_b32 v62, 15, 8, v62
    v_bfi_b32 v63, 15, 8, v63
    v_lshlrev_b32 v8, 3, v1
    v_add_u32 v8, 145408, v8
    v_pk_add_f32 v[48:49], v[48:49], v[52:53]
    v_pk_add_f32 v[50:51], v[50:51], v[54:55]
    v_pk_add_f32 v[56:57], v[56:57], v[60:61]
    v_pk_add_f32 v[58:59], v[58:59], v[62:63]
    v_pk_add_f32 v[48:49], v[48:49], v[56:57]
    v_pk_add_f32 v[50:51], v[50:51], v[58:59]
    v_cvt_pk_bf16_f32 v48, v48, v49
    v_cvt_pk_bf16_f32 v49, v50, v51
    ds_write_b64 v8, v[48:49]
    s_setprio 0
    s_branch L_qdone
L_stream:
    s_setprio 3
    v_and_b32 v2, 3, v1
    v_lshlrev_b32 v2, 4, v2
    v_lshrrev_b32 v9, 4, v1
    v_lshl_add_u32 v2, v9, 6, v2
    v_bfe_u32 v9, v1, 2, 1
    v_lshl_add_u32 v2, v9, 10, v2
    v_bfe_u32 v9, v1, 3, 1
    v_lshl_add_u32 v2, v9, 13, v2
    s_and_b32 s50, s3, 1
    s_lshl_b32 s50, s50, 11
    s_lshr_b32 s51, s3, 1
    s_lshl_b32 s51, s51, 12
    s_or_b32 s50, s50, s51
    v_add_u32 v2, s50, v2
    s_lshl_b32 s51, s2, 20
    s_mov_b32 s22, 0x100000
    s_mov_b32 s23, 0x20000
    s_mov_b32 s53, 0
    s_waitcnt lgkmcnt(0)
    s_add_u32 s20, s6, s51
    s_addc_u32 s21, s7, 0
    s_and_b32 s21, s21, 0xffff
    buffer_load_dwordx4 v[32:35], v2, s[20:23], s53 offen offset:0 nt
    s_waitcnt vmcnt(0)
    s_mov_b32 s53, 0x10000
    buffer_load_dwordx4 v[36:39], v2, s[20:23], s53 offen offset:512 nt
    s_mov_b32 s53, 0x0
    buffer_load_dwordx4 v[40:43], v2, s[20:23], s53 offen offset:512 nt
    s_mov_b32 s53, 0x10000
    buffer_load_dwordx4 v[44:47], v2, s[20:23], s53 offen offset:0 nt
    s_mov_b32 s53, 0xa0000
    buffer_load_dwordx4 v[48:51], v2, s[20:23], s53 offen offset:0 nt
    s_add_u32 s24, s8, s51
    s_addc_u32 s25, s9, 0
    s_and_b32 s25, s25, 0xffff
    s_mov_b32 s26, 0x100000
    s_mov_b32 s27, 0x20000
    s_lshl_b32 s55, s49, 2
    s_add_u32 s55, s55, 983040
    s_load_dword s59, s[18:19], s55
    v_and_b32 v3, 15, v1
    v_lshlrev_b32 v3, 4, v3
    v_bfe_u32 v9, v1, 4, 1
    v_lshl_add_u32 v3, v9, 10, v3
    v_bfe_u32 v9, v1, 5, 1
    v_lshl_add_u32 v3, v9, 13, v3
    v_add_u32 v3, s50, v3
    s_lshl_b32 s52, s3, 13
    s_add_u32 s52, s52, 98304
    v_lshlrev_b32 v4, 2, v1
    v_add_u32 v4, s52, v4
    v_mov_b32 v5, 0xff800000
    s_mov_b32 s56, 0x3db504f3
    s_mov_b32 s57, 0x3fb8aa3b
    v_and_b32 v9, 2, v1
    v_cmp_eq_u32 vcc, 0, v9
    v_mov_b32 v10, 0x01000c0c
    v_mov_b32 v11, 0x0c0c0100
    v_cndmask_b32 v12, v10, v11, vcc
    v_mov_b32 v10, 0x03020c0c
    v_mov_b32 v11, 0x0c0c0302
    v_cndmask_b32 v13, v10, v11, vcc
    v_and_b32 v30, 1, v1
    v_lshlrev_b32 v30, 8, v30
    v_lshrrev_b32 v9, 2, v1
    v_lshl_add_u32 v30, v9, 4, v30
    v_add_u32 v30, 145408, v30
    s_waitcnt vmcnt(4)
    s_mov_b32 s53, 0xb0000
    buffer_load_dwordx4 v[52:55], v2, s[20:23], s53 offen offset:512 nt
    s_waitcnt vmcnt(4)
    s_mov_b32 s53, 0xa0000
    buffer_load_dwordx4 v[56:59], v2, s[20:23], s53 offen offset:512 nt
    s_waitcnt vmcnt(4)
    s_mov_b32 s53, 0xb0000
    buffer_load_dwordx4 v[60:63], v2, s[20:23], s53 offen offset:0 nt
    s_waitcnt vmcnt(4)
    s_mov_b32 s53, 0x8000
    buffer_load_dwordx4 v[64:67], v2, s[20:23], s53 offen offset:256 nt
    s_waitcnt vmcnt(4)
    s_mov_b32 s53, 0x18000
    buffer_load_dwordx4 v[68:71], v2, s[20:23], s53 offen offset:768 nt
    s_waitcnt vmcnt(4)
    s_mov_b32 s53, 0x8000
    buffer_load_dwordx4 v[72:75], v2, s[20:23], s53 offen offset:768 nt
    s_waitcnt vmcnt(4)
    s_mov_b32 s53, 0x18000
    buffer_load_dwordx4 v[76:79], v2, s[20:23], s53 offen offset:256 nt
    s_waitcnt vmcnt(4)
    s_mov_b32 s53, 0xa8000
    buffer_load_dwordx4 v[80:83], v2, s[20:23], s53 offen offset:256 nt
    s_waitcnt vmcnt(4)
    s_mov_b32 s53, 0xb8000
    buffer_load_dwordx4 v[84:87], v2, s[20:23], s53 offen offset:768 nt
    s_waitcnt vmcnt(4)
    s_mov_b32 s53, 0xa8000
    buffer_load_dwordx4 v[88:91], v2, s[20:23], s53 offen offset:768 nt
    s_waitcnt vmcnt(4)
    s_mov_b32 s53, 0xb8000
    buffer_load_dwordx4 v[92:95], v2, s[20:23], s53 offen offset:256 nt
    s_waitcnt vmcnt(4)
    s_mov_b32 s53, 0x20000
    buffer_load_dwordx4 v[96:99], v2, s[20:23], s53 offen offset:0 nt
    s_waitcnt vmcnt(4)
    s_mov_b32 s53, 0x30000
    buffer_load_dwordx4 v[100:103], v2, s[20:23], s53 offen offset:512 nt
    s_waitcnt vmcnt(4)
    s_mov_b32 s53, 0x20000
    buffer_load_dwordx4 v[104:107], v2, s[20:23], s53 offen offset:512 nt
    s_waitcnt vmcnt(4)
    s_mov_b32 s53, 0x30000
    buffer_load_dwordx4 v[108:111], v2, s[20:23], s53 offen offset:0 nt
    s_waitcnt vmcnt(4)
    s_mov_b32 s53, 0x80000
    buffer_load_dwordx4 v[112:115], v2, s[20:23], s53 offen offset:0 nt
    s_waitcnt vmcnt(4)
    s_mov_b32 s53, 0x90000
    buffer_load_dwordx4 v[116:119], v2, s[20:23], s53 offen offset:512 nt
    s_waitcnt vmcnt(4)
    s_mov_b32 s53, 0x80000
    buffer_load_dwordx4 v[120:123], v2, s[20:23], s53 offen offset:512 nt
    s_waitcnt vmcnt(4)
    s_mov_b32 s53, 0x90000
    buffer_load_dwordx4 v[124:127], v2, s[20:23], s53 offen offset:0 nt
    s_waitcnt vmcnt(4)
    s_mov_b32 s53, 0x28000
    buffer_load_dwordx4 v[128:131], v2, s[20:23], s53 offen offset:256 nt
    s_waitcnt vmcnt(4)
    s_mov_b32 s53, 0x38000
    buffer_load_dwordx4 v[132:135], v2, s[20:23], s53 offen offset:768 nt
    s_waitcnt vmcnt(4)
    s_mov_b32 s53, 0x28000
    buffer_load_dwordx4 v[136:139], v2, s[20:23], s53 offen offset:768 nt
    s_waitcnt vmcnt(4)
    s_mov_b32 s53, 0x38000
    buffer_load_dwordx4 v[140:143], v2, s[20:23], s53 offen offset:256 nt
    s_waitcnt vmcnt(4)
    s_mov_b32 s53, 0x88000
    buffer_load_dwordx4 v[144:147], v2, s[20:23], s53 offen offset:256 nt
    s_barrier
    s_waitcnt vmcnt(4)
    s_mov_b32 s53, 0x98000
    buffer_load_dwordx4 v[148:151], v2, s[20:23], s53 offen offset:768 nt
    s_waitcnt vmcnt(4)
    s_mov_b32 s53, 0x88000
    buffer_load_dwordx4 v[152:155], v2, s[20:23], s53 offen offset:768 nt
    s_waitcnt vmcnt(4)
    s_mov_b32 s53, 0x98000
    buffer_load_dwordx4 v[156:159], v2, s[20:23], s53 offen offset:256 nt
    s_waitcnt vmcnt(4)
    s_mov_b32 s53, 0xa4000
    buffer_load_dwordx4 v[160:163], v2, s[20:23], s53 offen offset:0 nt
    s_waitcnt vmcnt(4)
    s_mov_b32 s53, 0xb4000
    buffer_load_dwordx4 v[164:167], v2, s[20:23], s53 offen offset:512 nt
    s_waitcnt vmcnt(4)
    s_mov_b32 s53, 0xa4000
    buffer_load_dwordx4 v[168:171], v2, s[20:23], s53 offen offset:512 nt
    s_waitcnt vmcnt(4)
    s_mov_b32 s53, 0xb4000
    buffer_load_dwordx4 v[172:175], v2, s[20:23], s53 offen offset:0 nt
    s_waitcnt vmcnt(4)
    s_mov_b32 s53, 0x4000
    buffer_load_dwordx4 v[176:179], v2, s[20:23], s53 offen offset:0 nt
    s_waitcnt vmcnt(4)
    s_mov_b32 s53, 0x14000
    buffer_load_dwordx4 v[180:183], v2, s[20:23], s53 offen offset:512 nt
    s_waitcnt vmcnt(4)
    s_mov_b32 s53, 0x4000
    buffer_load_dwordx4 v[184:187], v2, s[20:23], s53 offen offset:512 nt
    s_waitcnt vmcnt(4)
    s_mov_b32 s53, 0x14000
    buffer_load_dwordx4 v[188:191], v2, s[20:23], s53 offen offset:0 nt
    s_waitcnt vmcnt(4)
    s_mov_b32 s53, 0xac000
    buffer_load_dwordx4 v[192:195], v2, s[20:23], s53 offen offset:256 nt
    s_waitcnt vmcnt(4)
    s_mov_b32 s53, 0xbc000
    buffer_load_dwordx4 v[196:199], v2, s[20:23], s53 offen offset:768 nt
    s_waitcnt vmcnt(4)
    s_mov_b32 s53, 0xac000
    buffer_load_dwordx4 v[200:203], v2, s[20:23], s53 offen offset:768 nt
    s_waitcnt vmcnt(4)
    s_mov_b32 s53, 0xbc000
    buffer_load_dwordx4 v[204:207], v2, s[20:23], s53 offen offset:256 nt
    s_waitcnt vmcnt(4)
    s_mov_b32 s53, 0xc000
    buffer_load_dwordx4 v[208:211], v2, s[20:23], s53 offen offset:256 nt
    s_waitcnt vmcnt(4)
    s_mov_b32 s53, 0x1c000
    buffer_load_dwordx4 v[212:215], v2, s[20:23], s53 offen offset:768 nt
    s_waitcnt vmcnt(4)
    s_mov_b32 s53, 0xc000
    buffer_load_dwordx4 v[216:219], v2, s[20:23], s53 offen offset:768 nt
    s_waitcnt vmcnt(4)
    s_mov_b32 s53, 0x1c000
    buffer_load_dwordx4 v[220:223], v2, s[20:23], s53 offen offset:256 nt
    s_waitcnt vmcnt(4)
    s_mov_b32 s53, 0x84000
    buffer_load_dwordx4 v[224:227], v2, s[20:23], s53 offen offset:0 nt
    s_waitcnt vmcnt(4)
    s_mov_b32 s53, 0x94000
    buffer_load_dwordx4 v[228:231], v2, s[20:23], s53 offen offset:512 nt
    s_waitcnt vmcnt(4)
    s_mov_b32 s53, 0x84000
    buffer_load_dwordx4 v[232:235], v2, s[20:23], s53 offen offset:512 nt
    s_waitcnt vmcnt(4)
    s_mov_b32 s53, 0x94000
    buffer_load_dwordx4 v[236:239], v2, s[20:23], s53 offen offset:0 nt
    s_waitcnt vmcnt(4)
    s_mov_b32 s53, 0x24000
    buffer_load_dwordx4 v[240:243], v2, s[20:23], s53 offen offset:0 nt
    s_waitcnt vmcnt(4)
    s_mov_b32 s53, 0x34000
    buffer_load_dwordx4 v[244:247], v2, s[20:23], s53 offen offset:512 nt
    s_waitcnt vmcnt(4)
    s_mov_b32 s53, 0x24000
    buffer_load_dwordx4 v[248:251], v2, s[20:23], s53 offen offset:512 nt
    s_waitcnt vmcnt(4)
    s_mov_b32 s53, 0x34000
    buffer_load_dwordx4 v[252:255], v2, s[20:23], s53 offen offset:0 nt
    s_barrier
    ds_read_b128 v[16:19], v30
    s_waitcnt lgkmcnt(0)
    v_mfma_f32_16x16x32_bf16 v[20:23], v[32:35], v[16:19], 0
    s_nop 0
    s_nop 0
    s_nop 0
    v_mfma_f32_16x16x32_bf16 v[32:35], v[36:39], v[16:19], 0
    s_nop 0
    s_nop 0
    s_nop 0
    v_mfma_f32_16x16x32_bf16 v[36:39], v[40:43], v[16:19], 0
    s_nop 0
    s_nop 0
    v_add_f32_dpp v14, v21, v20 row_ror:12 row_mask:0xf bank_mask:0xf
    v_mfma_f32_16x16x32_bf16 v[40:43], v[44:47], v[16:19], 0
    s_nop 0
    v_add_f32_dpp v14, v22, v14 row_ror:8 row_mask:0xf bank_mask:0xf
    v_add_f32_dpp v15, v32, v33 row_ror:4 row_mask:0xf bank_mask:0xf
    v_mfma_f32_16x16x32_bf16 v[44:47], v[48:51], v[16:19], 0
    v_add_f32_dpp v7, v23, v14 row_ror:4 row_mask:0xf bank_mask:0x1
    v_add_f32_dpp v15, v34, v15 row_ror:12 row_mask:0xf bank_mask:0xf
    v_add_f32_dpp v31, v36, v38 row_ror:8 row_mask:0xf bank_mask:0xf
    v_mfma_f32_16x16x32_bf16 v[48:51], v[52:55], v[16:19], 0
    v_add_f32_dpp v7, v35, v15 row_ror:8 row_mask:0xf bank_mask:0x2
    v_add_f32_dpp v31, v37, v31 row_ror:4 row_mask:0xf bank_mask:0xf
    v_add_f32_dpp v14, v40, v43 row_ror:12 row_mask:0xf bank_mask:0xf
    s_waitcnt vmcnt(4)
    s_mov_b32 s53, 0x8c000
    buffer_load_dwordx4 v[32:35], v2, s[20:23], s53 offen offset:256 nt
    v_mfma_f32_16x16x32_bf16 v[52:55], v[56:59], v[16:19], 0
    v_add_f32_dpp v7, v39, v31 row_ror:12 row_mask:0xf bank_mask:0x4
    v_add_f32_dpp v14, v41, v14 row_ror:8 row_mask:0xf bank_mask:0xf
    v_add_f32_dpp v15, v45, v44 row_ror:12 row_mask:0xf bank_mask:0xf
    v_mfma_f32_16x16x32_bf16 v[56:59], v[60:63], v[16:19], 0
    v_add_f32_dpp v7, v42, v14 row_ror:4 row_mask:0xf bank_mask:0x8
    v_add_f32_dpp v15, v46, v15 row_ror:8 row_mask:0xf bank_mask:0xf
    v_add_f32_dpp v31, v48, v49 row_ror:4 row_mask:0xf bank_mask:0xf
    v_mfma_f32_16x16x32_bf16 v[60:63], v[64:67], v[16:19], 0
    v_add_f32_dpp v8, v47, v15 row_ror:4 row_mask:0xf bank_mask:0x1
    v_add_f32_dpp v31, v50, v31 row_ror:12 row_mask:0xf bank_mask:0xf
    v_add_f32_dpp v14, v52, v54 row_ror:8 row_mask:0xf bank_mask:0xf
    v_mfma_f32_16x16x32_bf16 v[64:67], v[68:71], v[16:19], 0
    v_add_f32_dpp v8, v51, v31 row_ror:8 row_mask:0xf bank_mask:0x2
    v_add_f32_dpp v14, v53, v14 row_ror:4 row_mask:0xf bank_mask:0xf
    v_add_f32_dpp v15, v56, v59 row_ror:12 row_mask:0xf bank_mask:0xf
    v_mfma_f32_16x16x32_bf16 v[68:71], v[72:75], v[16:19], 0
    v_add_f32_dpp v8, v55, v14 row_ror:12 row_mask:0xf bank_mask:0x4
    v_add_f32_dpp v15, v57, v15 row_ror:8 row_mask:0xf bank_mask:0xf
    v_add_f32_dpp v31, v61, v60 row_ror:12 row_mask:0xf bank_mask:0xf
    v_mfma_f32_16x16x32_bf16 v[72:75], v[76:79], v[16:19], 0
    v_add_f32_dpp v8, v58, v15 row_ror:4 row_mask:0xf bank_mask:0x8
    v_add_f32_dpp v31, v62, v31 row_ror:8 row_mask:0xf bank_mask:0xf
    v_add_f32_dpp v14, v64, v65 row_ror:4 row_mask:0xf bank_mask:0xf
    v_cvt_pk_bf16_f32 v9, v7, v8
    v_lshlrev_b32 v10, 16, v9
    v_and_b32 v11, 0xffff0000, v9
    v_mul_f32 v10, s56, v10
    v_mul_f32 v11, s56, v11
    v_max3_f32 v5, v5, v10, v11
    v_cvt_pk_bf16_f32 v9, v10, v11
    ds_write_b32 v4, v9
    v_add_u32 v4, 0x100, v4
    v_mfma_f32_16x16x32_bf16 v[76:79], v[80:83], v[16:19], 0
    v_add_f32_dpp v7, v63, v31 row_ror:4 row_mask:0xf bank_mask:0x1
    v_add_f32_dpp v14, v66, v14 row_ror:12 row_mask:0xf bank_mask:0xf
    v_add_f32_dpp v15, v68, v70 row_ror:8 row_mask:0xf bank_mask:0xf
    s_waitcnt vmcnt(4)
    s_mov_b32 s53, 0x9c000
    buffer_load_dwordx4 v[36:39], v2, s[20:23], s53 offen offset:768 nt
    v_mfma_f32_16x16x32_bf16 v[80:83], v[84:87], v[16:19], 0
    v_add_f32_dpp v7, v67, v14 row_ror:8 row_mask:0xf bank_mask:0x2
    v_add_f32_dpp v15, v69, v15 row_ror:4 row_mask:0xf bank_mask:0xf
    v_add_f32_dpp v31, v72, v75 row_ror:12 row_mask:0xf bank_mask:0xf
    v_mfma_f32_16x16x32_bf16 v[84:87], v[88:91], v[16:19], 0
    v_add_f32_dpp v7, v71, v15 row_ror:12 row_mask:0xf bank_mask:0x4
    v_add_f32_dpp v31, v73, v31 row_ror:8 row_mask:0xf bank_mask:0xf
    v_add_f32_dpp v14, v77, v76 row_ror:12 row_mask:0xf bank_mask:0xf
    v_mfma_f32_16x16x32_bf16 v[88:91], v[92:95], v[16:19], 0
    v_add_f32_dpp v7, v74, v31 row_ror:4 row_mask:0xf bank_mask:0x8
    v_add_f32_dpp v14, v78, v14 row_ror:8 row_mask:0xf bank_mask:0xf
    v_add_f32_dpp v15, v80, v81 row_ror:4 row_mask:0xf bank_mask:0xf
    v_mfma_f32_16x16x32_bf16 v[92:95], v[96:99], v[16:19], 0
    v_add_f32_dpp v8, v79, v14 row_ror:4 row_mask:0xf bank_mask:0x1
    v_add_f32_dpp v15, v82, v15 row_ror:12 row_mask:0xf bank_mask:0xf
    v_add_f32_dpp v31, v84, v86 row_ror:8 row_mask:0xf bank_mask:0xf
    v_mfma_f32_16x16x32_bf16 v[96:99], v[100:103], v[16:19], 0
    v_add_f32_dpp v8, v83, v15 row_ror:8 row_mask:0xf bank_mask:0x2
    v_add_f32_dpp v31, v85, v31 row_ror:4 row_mask:0xf bank_mask:0xf
    v_add_f32_dpp v14, v88, v91 row_ror:12 row_mask:0xf bank_mask:0xf
    v_mfma_f32_16x16x32_bf16 v[100:103], v[104:107], v[16:19], 0
    v_add_f32_dpp v8, v87, v31 row_ror:12 row_mask:0xf bank_mask:0x4
    v_add_f32_dpp v14, v89, v14 row_ror:8 row_mask:0xf bank_mask:0xf
    v_add_f32_dpp v15, v93, v92 row_ror:12 row_mask:0xf bank_mask:0xf
    v_mfma_f32_16x16x32_bf16 v[104:107], v[108:111], v[16:19], 0
    v_add_f32_dpp v8, v90, v14 row_ror:4 row_mask:0xf bank_mask:0x8
    v_add_f32_dpp v15, v94, v15 row_ror:8 row_mask:0xf bank_mask:0xf
    v_add_f32_dpp v31, v96, v97 row_ror:4 row_mask:0xf bank_mask:0xf
    v_cvt_pk_bf16_f32 v9, v7, v8
    v_lshlrev_b32 v10, 16, v9
    v_and_b32 v11, 0xffff0000, v9
    v_mul_f32 v10, s56, v10
    v_mul_f32 v11, s56, v11
    v_max3_f32 v5, v5, v10, v11
    v_cvt_pk_bf16_f32 v9, v10, v11
    ds_write_b32 v4, v9
    v_add_u32 v4, 0x100, v4
    s_waitcnt vmcnt(5)
    s_mov_b32 s53, 0x8c000
    buffer_load_dwordx4 v[40:43], v2, s[20:23], s53 offen offset:768 nt
    v_mfma_f32_16x16x32_bf16 v[108:111], v[112:115], v[16:19], 0
    v_add_f32_dpp v7, v95, v15 row_ror:4 row_mask:0xf bank_mask:0x1
    v_add_f32_dpp v31, v98, v31 row_ror:12 row_mask:0xf bank_mask:0xf
    v_add_f32_dpp v14, v100, v102 row_ror:8 row_mask:0xf bank_mask:0xf
    v_mfma_f32_16x16x32_bf16 v[112:115], v[116:119], v[16:19], 0
    v_add_f32_dpp v7, v99, v31 row_ror:8 row_mask:0xf bank_mask:0x2
    v_add_f32_dpp v14, v101, v14 row_ror:4 row_mask:0xf bank_mask:0xf
    v_add_f32_dpp v15, v104, v107 row_ror:12 row_mask:0xf bank_mask:0xf
    v_mfma_f32_16x16x32_bf16 v[116:119], v[120:123], v[16:19], 0
    v_add_f32_dpp v7, v103, v14 row_ror:12 row_mask:0xf bank_mask:0x4
    v_add_f32_dpp v15, v105, v15 row_ror:8 row_mask:0xf bank_mask:0xf
    v_add_f32_dpp v31, v109, v108 row_ror:12 row_mask:0xf bank_mask:0xf
    v_mfma_f32_16x16x32_bf16 v[120:123], v[124:127], v[16:19], 0
    v_add_f32_dpp v7, v106, v15 row_ror:4 row_mask:0xf bank_mask:0x8
    v_add_f32_dpp v31, v110, v31 row_ror:8 row_mask:0xf bank_mask:0xf
    v_add_f32_dpp v14, v112, v113 row_ror:4 row_mask:0xf bank_mask:0xf
    v_mfma_f32_16x16x32_bf16 v[124:127], v[128:131], v[16:19], 0
    v_add_f32_dpp v8, v111, v31 row_ror:4 row_mask:0xf bank_mask:0x1
    v_add_f32_dpp v14, v114, v14 row_ror:12 row_mask:0xf bank_mask:0xf
    v_add_f32_dpp v15, v116, v118 row_ror:8 row_mask:0xf bank_mask:0xf
    v_mfma_f32_16x16x32_bf16 v[128:131], v[132:135], v[16:19], 0
    v_add_f32_dpp v8, v115, v14 row_ror:8 row_mask:0xf bank_mask:0x2
    v_add_f32_dpp v15, v117, v15 row_ror:4 row_mask:0xf bank_mask:0xf
    v_add_f32_dpp v31, v120, v123 row_ror:12 row_mask:0xf bank_mask:0xf
    v_mfma_f32_16x16x32_bf16 v[132:135], v[136:139], v[16:19], 0
    v_add_f32_dpp v8, v119, v15 row_ror:12 row_mask:0xf bank_mask:0x4
    v_add_f32_dpp v31, v121, v31 row_ror:8 row_mask:0xf bank_mask:0xf
    v_add_f32_dpp v14, v125, v124 row_ror:12 row_mask:0xf bank_mask:0xf
    s_waitcnt vmcnt(5)
    s_mov_b32 s53, 0x9c000
    buffer_load_dwordx4 v[44:47], v2, s[20:23], s53 offen offset:256 nt
    v_mfma_f32_16x16x32_bf16 v[136:139], v[140:143], v[16:19], 0
    v_add_f32_dpp v8, v122, v31 row_ror:4 row_mask:0xf bank_mask:0x8
    v_add_f32_dpp v14, v126, v14 row_ror:8 row_mask:0xf bank_mask:0xf
    v_add_f32_dpp v15, v128, v129 row_ror:4 row_mask:0xf bank_mask:0xf
    v_cvt_pk_bf16_f32 v9, v7, v8
    v_lshlrev_b32 v10, 16, v9
    v_and_b32 v11, 0xffff0000, v9
    v_mul_f32 v10, s56, v10
    v_mul_f32 v11, s56, v11
    v_max3_f32 v5, v5, v10, v11
    v_cvt_pk_bf16_f32 v9, v10, v11
    ds_write_b32 v4, v9
    v_add_u32 v4, 0x100, v4
    v_mfma_f32_16x16x32_bf16 v[140:143], v[144:147], v[16:19], 0
    v_add_f32_dpp v7, v127, v14 row_ror:4 row_mask:0xf bank_mask:0x1
    v_add_f32_dpp v15, v130, v15 row_ror:12 row_mask:0xf bank_mask:0xf
    v_add_f32_dpp v31, v132, v134 row_ror:8 row_mask:0xf bank_mask:0xf
    v_mfma_f32_16x16x32_bf16 v[144:147], v[148:151], v[16:19], 0
    v_add_f32_dpp v7, v131, v15 row_ror:8 row_mask:0xf bank_mask:0x2
    v_add_f32_dpp v31, v133, v31 row_ror:4 row_mask:0xf bank_mask:0xf
    v_add_f32_dpp v14, v136, v139 row_ror:12 row_mask:0xf bank_mask:0xf
    v_mfma_f32_16x16x32_bf16 v[148:151], v[152:155], v[16:19], 0
    v_add_f32_dpp v7, v135, v31 row_ror:12 row_mask:0xf bank_mask:0x4
    v_add_f32_dpp v14, v137, v14 row_ror:8 row_mask:0xf bank_mask:0xf
    v_add_f32_dpp v15, v141, v140 row_ror:12 row_mask:0xf bank_mask:0xf
    v_mfma_f32_16x16x32_bf16 v[152:155], v[156:159], v[16:19], 0
    v_add_f32_dpp v7, v138, v14 row_ror:4 row_mask:0xf bank_mask:0x8
    v_add_f32_dpp v15, v142, v15 row_ror:8 row_mask:0xf bank_mask:0xf
    v_add_f32_dpp v31, v144, v145 row_ror:4 row_mask:0xf bank_mask:0xf
    v_mfma_f32_16x16x32_bf16 v[156:159], v[160:163], v[16:19], 0
    v_add_f32_dpp v8, v143, v15 row_ror:4 row_mask:0xf bank_mask:0x1
    v_add_f32_dpp v31, v146, v31 row_ror:12 row_mask:0xf bank_mask:0xf
    v_add_f32_dpp v14, v148, v150 row_ror:8 row_mask:0xf bank_mask:0xf
    v_mfma_f32_16x16x32_bf16 v[160:163], v[164:167], v[16:19], 0
    v_add_f32_dpp v8, v147, v31 row_ror:8 row_mask:0xf bank_mask:0x2
    v_add_f32_dpp v14, v149, v14 row_ror:4 row_mask:0xf bank_mask:0xf
    v_add_f32_dpp v15, v152, v155 row_ror:12 row_mask:0xf bank_mask:0xf
    s_waitcnt vmcnt(4)
    s_mov_b32 s53, 0x2c000
    buffer_load_dwordx4 v[48:51], v2, s[20:23], s53 offen offset:256 nt
    v_mfma_f32_16x16x32_bf16 v[164:167], v[168:171], v[16:19], 0
    v_add_f32_dpp v8, v151, v14 row_ror:12 row_mask:0xf bank_mask:0x4
    v_add_f32_dpp v15, v153, v15 row_ror:8 row_mask:0xf bank_mask:0xf
    v_add_f32_dpp v31, v157, v156 row_ror:12 row_mask:0xf bank_mask:0xf
    v_mfma_f32_16x16x32_bf16 v[168:171], v[172:175], v[16:19], 0
    v_add_f32_dpp v8, v154, v15 row_ror:4 row_mask:0xf bank_mask:0x8
    v_add_f32_dpp v31, v158, v31 row_ror:8 row_mask:0xf bank_mask:0xf
    v_add_f32_dpp v14, v160, v161 row_ror:4 row_mask:0xf bank_mask:0xf
    v_cvt_pk_bf16_f32 v9, v7, v8
    v_lshlrev_b32 v10, 16, v9
    v_and_b32 v11, 0xffff0000, v9
    v_mul_f32 v10, s56, v10
    v_mul_f32 v11, s56, v11
    v_max3_f32 v5, v5, v10, v11
    v_cvt_pk_bf16_f32 v9, v10, v11
    ds_write_b32 v4, v9
    v_add_u32 v4, 0x100, v4
    v_mfma_f32_16x16x32_bf16 v[172:175], v[176:179], v[16:19], 0
    v_add_f32_dpp v7, v159, v31 row_ror:4 row_mask:0xf bank_mask:0x1
    v_add_f32_dpp v14, v162, v14 row_ror:12 row_mask:0xf bank_mask:0xf
    v_add_f32_dpp v15, v164, v166 row_ror:8 row_mask:0xf bank_mask:0xf
    v_mfma_f32_16x16x32_bf16 v[176:179], v[180:183], v[16:19], 0
    v_add_f32_dpp v7, v163, v14 row_ror:8 row_mask:0xf bank_mask:0x2
    v_add_f32_dpp v15, v165, v15 row_ror:4 row_mask:0xf bank_mask:0xf
    v_add_f32_dpp v31, v168, v171 row_ror:12 row_mask:0xf bank_mask:0xf
    v_mfma_f32_16x16x32_bf16 v[180:183], v[184:187], v[16:19], 0
    v_add_f32_dpp v7, v167, v15 row_ror:12 row_mask:0xf bank_mask:0x4
    v_add_f32_dpp v31, v169, v31 row_ror:8 row_mask:0xf bank_mask:0xf
    v_add_f32_dpp v14, v173, v172 row_ror:12 row_mask:0xf bank_mask:0xf
    v_mfma_f32_16x16x32_bf16 v[184:187], v[188:191], v[16:19], 0
    v_add_f32_dpp v7, v170, v31 row_ror:4 row_mask:0xf bank_mask:0x8
    v_add_f32_dpp v14, v174, v14 row_ror:8 row_mask:0xf bank_mask:0xf
    v_add_f32_dpp v15, v176, v177 row_ror:4 row_mask:0xf bank_mask:0xf
    v_mfma_f32_16x16x32_bf16 v[188:191], v[192:195], v[16:19], 0
    v_add_f32_dpp v8, v175, v14 row_ror:4 row_mask:0xf bank_mask:0x1
    v_add_f32_dpp v15, v178, v15 row_ror:12 row_mask:0xf bank_mask:0xf
    v_add_f32_dpp v31, v180, v182 row_ror:8 row_mask:0xf bank_mask:0xf
    s_waitcnt vmcnt(4)
    s_mov_b32 s53, 0x3c000
    buffer_load_dwordx4 v[52:55], v2, s[20:23], s53 offen offset:768 nt
    v_mfma_f32_16x16x32_bf16 v[192:195], v[196:199], v[16:19], 0
    v_add_f32_dpp v8, v179, v15 row_ror:8 row_mask:0xf bank_mask:0x2
    v_add_f32_dpp v31, v181, v31 row_ror:4 row_mask:0xf bank_mask:0xf
    v_add_f32_dpp v14, v184, v187 row_ror:12 row_mask:0xf bank_mask:0xf
    v_mfma_f32_16x16x32_bf16 v[196:199], v[200:203], v[16:19], 0
    v_add_f32_dpp v8, v183, v31 row_ror:12 row_mask:0xf bank_mask:0x4
    v_add_f32_dpp v14, v185, v14 row_ror:8 row_mask:0xf bank_mask:0xf
    v_add_f32_dpp v15, v189, v188 row_ror:12 row_mask:0xf bank_mask:0xf
    v_mfma_f32_16x16x32_bf16 v[200:203], v[204:207], v[16:19], 0
    v_add_f32_dpp v8, v186, v14 row_ror:4 row_mask:0xf bank_mask:0x8
    v_add_f32_dpp v15, v190, v15 row_ror:8 row_mask:0xf bank_mask:0xf
    v_add_f32_dpp v31, v192, v193 row_ror:4 row_mask:0xf bank_mask:0xf
    v_cvt_pk_bf16_f32 v9, v7, v8
    v_lshlrev_b32 v10, 16, v9
    v_and_b32 v11, 0xffff0000, v9
    v_mul_f32 v10, s56, v10
    v_mul_f32 v11, s56, v11
    v_max3_f32 v5, v5, v10, v11
    v_cvt_pk_bf16_f32 v9, v10, v11
    ds_write_b32 v4, v9
    v_add_u32 v4, 0x100, v4
    v_mfma_f32_16x16x32_bf16 v[204:207], v[208:211], v[16:19], 0
    v_add_f32_dpp v7, v191, v15 row_ror:4 row_mask:0xf bank_mask:0x1
    v_add_f32_dpp v31, v194, v31 row_ror:12 row_mask:0xf bank_mask:0xf
    v_add_f32_dpp v14, v196, v198 row_ror:8 row_mask:0xf bank_mask:0xf
    v_mfma_f32_16x16x32_bf16 v[208:211], v[212:215], v[16:19], 0
    v_add_f32_dpp v7, v195, v31 row_ror:8 row_mask:0xf bank_mask:0x2
    v_add_f32_dpp v14, v197, v14 row_ror:4 row_mask:0xf bank_mask:0xf
    v_add_f32_dpp v15, v200, v203 row_ror:12 row_mask:0xf bank_mask:0xf
    v_mfma_f32_16x16x32_bf16 v[212:215], v[216:219], v[16:19], 0
    v_add_f32_dpp v7, v199, v14 row_ror:12 row_mask:0xf bank_mask:0x4
    v_add_f32_dpp v15, v201, v15 row_ror:8 row_mask:0xf bank_mask:0xf
    v_add_f32_dpp v31, v205, v204 row_ror:12 row_mask:0xf bank_mask:0xf
    v_mfma_f32_16x16x32_bf16 v[216:219], v[220:223], v[16:19], 0
    v_add_f32_dpp v7, v202, v15 row_ror:4 row_mask:0xf bank_mask:0x8
    v_add_f32_dpp v31, v206, v31 row_ror:8 row_mask:0xf bank_mask:0xf
    v_add_f32_dpp v14, v208, v209 row_ror:4 row_mask:0xf bank_mask:0xf
    s_waitcnt vmcnt(5)
    s_mov_b32 s53, 0x2c000
    buffer_load_dwordx4 v[56:59], v2, s[20:23], s53 offen offset:768 nt
    s_waitcnt vmcnt(14)
    v_mfma_f32_16x16x32_bf16 v[220:223], v[224:227], v[16:19], 0
    v_add_f32_dpp v8, v207, v31 row_ror:4 row_mask:0xf bank_mask:0x1
    v_add_f32_dpp v14, v210, v14 row_ror:12 row_mask:0xf bank_mask:0xf
    v_add_f32_dpp v15, v212, v214 row_ror:8 row_mask:0xf bank_mask:0xf
    s_waitcnt vmcnt(13)
    v_mfma_f32_16x16x32_bf16 v[224:227], v[228:231], v[16:19], 0
    v_add_f32_dpp v8, v211, v14 row_ror:8 row_mask:0xf bank_mask:0x2
    v_add_f32_dpp v15, v213, v15 row_ror:4 row_mask:0xf bank_mask:0xf
    v_add_f32_dpp v31, v216, v219 row_ror:12 row_mask:0xf bank_mask:0xf
    s_waitcnt vmcnt(12)
    v_mfma_f32_16x16x32_bf16 v[228:231], v[232:235], v[16:19], 0
    v_add_f32_dpp v8, v215, v15 row_ror:12 row_mask:0xf bank_mask:0x4
    v_add_f32_dpp v31, v217, v31 row_ror:8 row_mask:0xf bank_mask:0xf
    v_add_f32_dpp v14, v221, v220 row_ror:12 row_mask:0xf bank_mask:0xf
    s_waitcnt vmcnt(11)
    v_mfma_f32_16x16x32_bf16 v[232:235], v[236:239], v[16:19], 0
    v_add_f32_dpp v8, v218, v31 row_ror:4 row_mask:0xf bank_mask:0x8
    v_add_f32_dpp v14, v222, v14 row_ror:8 row_mask:0xf bank_mask:0xf
    v_add_f32_dpp v15, v224, v225 row_ror:4 row_mask:0xf bank_mask:0xf
    v_cvt_pk_bf16_f32 v9, v7, v8
    v_lshlrev_b32 v10, 16, v9
    v_and_b32 v11, 0xffff0000, v9
    v_mul_f32 v10, s56, v10
    v_mul_f32 v11, s56, v11
    v_max3_f32 v5, v5, v10, v11
    v_cvt_pk_bf16_f32 v9, v10, v11
    ds_write_b32 v4, v9
    v_add_u32 v4, 0x100, v4
    s_waitcnt vmcnt(10)
    v_mfma_f32_16x16x32_bf16 v[236:239], v[240:243], v[16:19], 0
    v_add_f32_dpp v7, v223, v14 row_ror:4 row_mask:0xf bank_mask:0x1
    v_add_f32_dpp v15, v226, v15 row_ror:12 row_mask:0xf bank_mask:0xf
    v_add_f32_dpp v31, v228, v230 row_ror:8 row_mask:0xf bank_mask:0xf
    s_waitcnt vmcnt(9)
    v_mfma_f32_16x16x32_bf16 v[240:243], v[244:247], v[16:19], 0
    v_add_f32_dpp v7, v227, v15 row_ror:8 row_mask:0xf bank_mask:0x2
    v_add_f32_dpp v31, v229, v31 row_ror:4 row_mask:0xf bank_mask:0xf
    v_add_f32_dpp v14, v232, v235 row_ror:12 row_mask:0xf bank_mask:0xf
    s_waitcnt vmcnt(8)
    v_mfma_f32_16x16x32_bf16 v[244:247], v[248:251], v[16:19], 0
    v_add_f32_dpp v7, v231, v31 row_ror:12 row_mask:0xf bank_mask:0x4
    v_add_f32_dpp v14, v233, v14 row_ror:8 row_mask:0xf bank_mask:0xf
    v_add_f32_dpp v15, v237, v236 row_ror:12 row_mask:0xf bank_mask:0xf
    s_waitcnt vmcnt(7)
    v_mfma_f32_16x16x32_bf16 v[24:27], v[252:255], v[16:19], 0
    v_add_f32_dpp v7, v234, v14 row_ror:4 row_mask:0xf bank_mask:0x8
    v_add_f32_dpp v15, v238, v15 row_ror:8 row_mask:0xf bank_mask:0xf
    v_add_f32_dpp v31, v240, v241 row_ror:4 row_mask:0xf bank_mask:0xf
    s_nop 0
    v_add_f32_dpp v8, v239, v15 row_ror:4 row_mask:0xf bank_mask:0x1
    v_add_f32_dpp v31, v242, v31 row_ror:12 row_mask:0xf bank_mask:0xf
    v_add_f32_dpp v14, v244, v246 row_ror:8 row_mask:0xf bank_mask:0xf
    s_nop 0
    v_add_f32_dpp v8, v243, v31 row_ror:8 row_mask:0xf bank_mask:0x2
    v_add_f32_dpp v14, v245, v14 row_ror:4 row_mask:0xf bank_mask:0xf
    s_nop 0
    s_nop 0
    v_add_f32_dpp v8, v247, v14 row_ror:12 row_mask:0xf bank_mask:0x4
    s_nop 0
    s_nop 0
    s_mov_b32 s58, 24
    s_mov_b32 s62, 7
    s_bitcmp1_b32 s62, 0
    s_cselect_b32 s28, 0x8100, 0
    s_bitcmp1_b32 s62, 1
    s_cselect_b32 s63, 0x20000, 0
    s_xor_b32 s28, s28, s63
    s_bitcmp1_b32 s62, 2
    s_cselect_b32 s63, 0xa4000, 0
    s_xor_b32 s28, s28, s63
    s_bitcmp1_b32 s62, 3
    s_cselect_b32 s63, 0x44000, 0
    s_xor_b32 s28, s28, s63
    s_bitcmp1_b32 s62, 4
    s_cselect_b32 s63, 0x100, 0
    s_xor_b32 s28, s28, s63
    s_xor_b32 s29, s28, 0x10000
    s_xor_b32 s30, s28, 0xa0000
    s_xor_b32 s31, s28, 0xb0000
L_kloop:
    s_waitcnt vmcnt(5)
    buffer_load_dwordx4 v[60:63], v2, s[20:23], s31 offen offset:0 nt
    s_add_u32 s62, s62, 1
    s_bitcmp1_b32 s62, 0
    s_cselect_b32 s28, 0x8100, 0
    s_bitcmp1_b32 s62, 1
    s_cselect_b32 s63, 0x20000, 0
    s_xor_b32 s28, s28, s63
    s_bitcmp1_b32 s62, 2
    s_cselect_b32 s63, 0xa4000, 0
    s_xor_b32 s28, s28, s63
    s_bitcmp1_b32 s62, 3
    s_cselect_b32 s63, 0x44000, 0
    s_xor_b32 s28, s28, s63
    s_bitcmp1_b32 s62, 4
    s_cselect_b32 s63, 0x100, 0
    s_xor_b32 s28, s28, s63
    s_xor_b32 s29, s28, 0x10000
    s_xor_b32 s30, s28, 0xa0000
    s_xor_b32 s31, s28, 0xb0000
    v_mfma_f32_16x16x32_bf16 v[20:23], v[32:35], v[16:19], 0
    v_add_f32_dpp v31, v24, v27 row_ror:12 row_mask:0xf bank_mask:0xf
    s_nop 1
    v_add_f32_dpp v31, v25, v31 row_ror:8 row_mask:0xf bank_mask:0xf
    s_nop 1
    v_add_f32_dpp v8, v26, v31 row_ror:4 row_mask:0xf bank_mask:0x8
    v_cvt_pk_bf16_f32 v9, v7, v8
    v_lshlrev_b32 v10, 16, v9
    v_and_b32 v11, 0xffff0000, v9
    v_mul_f32 v10, s56, v10
    v_mul_f32 v11, s56, v11
    v_max3_f32 v5, v5, v10, v11
    v_cvt_pk_bf16_f32 v9, v10, v11
    ds_write_b32 v4, v9
    v_add_u32 v4, 0x100, v4
    s_waitcnt vmcnt(4)
    buffer_load_dwordx4 v[32:35], v2, s[20:23], s28 offen offset:0 nt
    v_mfma_f32_16x16x32_bf16 v[24:27], v[36:39], v[16:19], 0
    v_add_f32_dpp v31, v21, v20 row_ror:12 row_mask:0xf bank_mask:0xf
    s_nop 1
    v_add_f32_dpp v31, v22, v31 row_ror:8 row_mask:0xf bank_mask:0xf
    s_nop 1
    v_add_f32_dpp v7, v23, v31 row_ror:4 row_mask:0xf bank_mask:0x1
    s_waitcnt vmcnt(4)
    buffer_load_dwordx4 v[36:39], v2, s[20:23], s29 offen offset:512 nt
    v_mfma_f32_16x16x32_bf16 v[20:23], v[40:43], v[16:19], 0
    v_add_f32_dpp v31, v24, v25 row_ror:4 row_mask:0xf bank_mask:0xf
    s_nop 1
    v_add_f32_dpp v31, v26, v31 row_ror:12 row_mask:0xf bank_mask:0xf
    s_nop 1
    v_add_f32_dpp v7, v27, v31 row_ror:8 row_mask:0xf bank_mask:0x2
    s_waitcnt vmcnt(5)
    buffer_load_dwordx4 v[40:43], v2, s[20:23], s28 offen offset:512 nt
    v_mfma_f32_16x16x32_bf16 v[24:27], v[44:47], v[16:19], 0
    v_add_f32_dpp v31, v20, v22 row_ror:8 row_mask:0xf bank_mask:0xf
    s_nop 1
    v_add_f32_dpp v31, v21, v31 row_ror:4 row_mask:0xf bank_mask:0xf
    s_nop 1
    v_add_f32_dpp v7, v23, v31 row_ror:12 row_mask:0xf bank_mask:0x4
    s_waitcnt vmcnt(5)
    buffer_load_dwordx4 v[44:47], v2, s[20:23], s29 offen offset:0 nt
    v_mfma_f32_16x16x32_bf16 v[20:23], v[48:51], v[16:19], 0
    v_add_f32_dpp v31, v24, v27 row_ror:12 row_mask:0xf bank_mask:0xf
    s_nop 1
    v_add_f32_dpp v31, v25, v31 row_ror:8 row_mask:0xf bank_mask:0xf
    s_nop 1
    v_add_f32_dpp v7, v26, v31 row_ror:4 row_mask:0xf bank_mask:0x8
    s_waitcnt vmcnt(4)
    buffer_load_dwordx4 v[48:51], v2, s[20:23], s30 offen offset:0 nt
    v_mfma_f32_16x16x32_bf16 v[24:27], v[52:55], v[16:19], 0
    v_add_f32_dpp v31, v21, v20 row_ror:12 row_mask:0xf bank_mask:0xf
    s_nop 1
    v_add_f32_dpp v31, v22, v31 row_ror:8 row_mask:0xf bank_mask:0xf
    s_nop 1
    v_add_f32_dpp v8, v23, v31 row_ror:4 row_mask:0xf bank_mask:0x1
    s_waitcnt vmcnt(4)
    buffer_load_dwordx4 v[52:55], v2, s[20:23], s31 offen offset:512 nt
    v_mfma_f32_16x16x32_bf16 v[20:23], v[56:59], v[16:19], 0
    v_add_f32_dpp v31, v24, v25 row_ror:4 row_mask:0xf bank_mask:0xf
    s_nop 1
    v_add_f32_dpp v31, v26, v31 row_ror:12 row_mask:0xf bank_mask:0xf
    s_nop 1
    v_add_f32_dpp v8, v27, v31 row_ror:8 row_mask:0xf bank_mask:0x2
    s_waitcnt vmcnt(5)
    buffer_load_dwordx4 v[56:59], v2, s[20:23], s30 offen offset:512 nt
    v_mfma_f32_16x16x32_bf16 v[24:27], v[60:63], v[16:19], 0
    v_add_f32_dpp v31, v20, v22 row_ror:8 row_mask:0xf bank_mask:0xf
    s_nop 1
    v_add_f32_dpp v31, v21, v31 row_ror:4 row_mask:0xf bank_mask:0xf
    s_nop 1
    v_add_f32_dpp v8, v23, v31 row_ror:12 row_mask:0xf bank_mask:0x4
    s_sub_u32 s58, s58, 1
    s_cmp_lg_u32 s58, 0
    s_cbranch_scc1 L_kloop
    s_waitcnt vmcnt(5)
    s_mov_b32 s53, 0x78000
    buffer_load_dwordx4 v[60:63], v2, s[20:23], s53 offen offset:0 nt
    v_mfma_f32_16x16x32_bf16 v[20:23], v[32:35], v[16:19], 0
    v_add_f32_dpp v31, v24, v27 row_ror:12 row_mask:0xf bank_mask:0xf
    s_nop 1
    v_add_f32_dpp v31, v25, v31 row_ror:8 row_mask:0xf bank_mask:0xf
    s_nop 1
    v_add_f32_dpp v8, v26, v31 row_ror:4 row_mask:0xf bank_mask:0x8
    v_cvt_pk_bf16_f32 v9, v7, v8
    v_lshlrev_b32 v10, 16, v9
    v_and_b32 v11, 0xffff0000, v9
    v_mul_f32 v10, s56, v10
    v_mul_f32 v11, s56, v11
    v_max3_f32 v5, v5, v10, v11
    v_cvt_pk_bf16_f32 v9, v10, v11
    ds_write_b32 v4, v9
    v_add_u32 v4, 0x100, v4
    s_waitcnt vmcnt(4)
    s_mov_b32 s53, 0x0
    buffer_load_dwordx4 v[32:35], v3, s[24:27], s53 offen offset:0 nt
    v_mfma_f32_16x16x32_bf16 v[24:27], v[36:39], v[16:19], 0
    v_add_f32_dpp v31, v21, v20 row_ror:12 row_mask:0xf bank_mask:0xf
    s_nop 1
    v_add_f32_dpp v31, v22, v31 row_ror:8 row_mask:0xf bank_mask:0xf
    s_nop 1
    v_add_f32_dpp v7, v23, v31 row_ror:4 row_mask:0xf bank_mask:0x1
    s_waitcnt vmcnt(4)
    s_mov_b32 s53, 0x10000
    buffer_load_dwordx4 v[36:39], v3, s[24:27], s53 offen offset:512 nt
    v_mfma_f32_16x16x32_bf16 v[20:23], v[40:43], v[16:19], 0
    v_add_f32_dpp v31, v24, v25 row_ror:4 row_mask:0xf bank_mask:0xf
    s_nop 1
    v_add_f32_dpp v31, v26, v31 row_ror:12 row_mask:0xf bank_mask:0xf
    s_nop 1
    v_add_f32_dpp v7, v27, v31 row_ror:8 row_mask:0xf bank_mask:0x2
    s_waitcnt vmcnt(4)
    s_mov_b32 s53, 0x0
    buffer_load_dwordx4 v[40:43], v3, s[24:27], s53 offen offset:512 nt
    v_mfma_f32_16x16x32_bf16 v[24:27], v[44:47], v[16:19], 0
    v_add_f32_dpp v31, v20, v22 row_ror:8 row_mask:0xf bank_mask:0xf
    s_nop 1
    v_add_f32_dpp v31, v21, v31 row_ror:4 row_mask:0xf bank_mask:0xf
    s_nop 1
    v_add_f32_dpp v7, v23, v31 row_ror:12 row_mask:0xf bank_mask:0x4
    s_waitcnt vmcnt(4)
    s_mov_b32 s53, 0x10000
    buffer_load_dwordx4 v[44:47], v3, s[24:27], s53 offen offset:0 nt
    v_mfma_f32_16x16x32_bf16 v[20:23], v[48:51], v[16:19], 0
    v_add_f32_dpp v31, v24, v27 row_ror:12 row_mask:0xf bank_mask:0xf
    s_nop 1
    v_add_f32_dpp v31, v25, v31 row_ror:8 row_mask:0xf bank_mask:0xf
    s_nop 1
    v_add_f32_dpp v7, v26, v31 row_ror:4 row_mask:0xf bank_mask:0x8
    s_waitcnt vmcnt(4)
    s_mov_b32 s53, 0xa0000
    buffer_load_dwordx4 v[48:51], v3, s[24:27], s53 offen offset:0 nt
    v_mfma_f32_16x16x32_bf16 v[24:27], v[52:55], v[16:19], 0
    v_add_f32_dpp v31, v21, v20 row_ror:12 row_mask:0xf bank_mask:0xf
    s_nop 1
    v_add_f32_dpp v31, v22, v31 row_ror:8 row_mask:0xf bank_mask:0xf
    s_nop 1
    v_add_f32_dpp v8, v23, v31 row_ror:4 row_mask:0xf bank_mask:0x1
    s_waitcnt vmcnt(4)
    s_mov_b32 s53, 0xb0000
    buffer_load_dwordx4 v[52:55], v3, s[24:27], s53 offen offset:512 nt
    v_mfma_f32_16x16x32_bf16 v[20:23], v[56:59], v[16:19], 0
    v_add_f32_dpp v31, v24, v25 row_ror:4 row_mask:0xf bank_mask:0xf
    s_nop 1
    v_add_f32_dpp v31, v26, v31 row_ror:12 row_mask:0xf bank_mask:0xf
    s_nop 1
    v_add_f32_dpp v8, v27, v31 row_ror:8 row_mask:0xf bank_mask:0x2
    s_waitcnt vmcnt(4)
    s_mov_b32 s53, 0xa0000
    buffer_load_dwordx4 v[56:59], v3, s[24:27], s53 offen offset:512 nt
    v_mfma_f32_16x16x32_bf16 v[24:27], v[60:63], v[16:19], 0
    v_add_f32_dpp v31, v20, v22 row_ror:8 row_mask:0xf bank_mask:0xf
    s_nop 1
    v_add_f32_dpp v31, v21, v31 row_ror:4 row_mask:0xf bank_mask:0xf
    s_nop 1
    v_add_f32_dpp v8, v23, v31 row_ror:12 row_mask:0xf bank_mask:0x4
    s_nop 1
    v_add_f32_dpp v31, v24, v27 row_ror:12 row_mask:0xf bank_mask:0xf
    s_nop 1
    v_add_f32_dpp v31, v25, v31 row_ror:8 row_mask:0xf bank_mask:0xf
    s_nop 1
    v_add_f32_dpp v8, v26, v31 row_ror:4 row_mask:0xf bank_mask:0x8
    v_cvt_pk_bf16_f32 v9, v7, v8
    v_lshlrev_b32 v10, 16, v9
    v_and_b32 v11, 0xffff0000, v9
    v_mul_f32 v10, s56, v10
    v_mul_f32 v11, s56, v11
    v_max3_f32 v5, v5, v10, v11
    v_cvt_pk_bf16_f32 v9, v10, v11
    ds_write_b32 v4, v9
    v_add_u32 v4, 0x100, v4
    v_subrev_u32 v4, 0x2000, v4
    ds_read_b32 v29, v4
    s_nop 1
    v_max_f32_dpp v5, v5, v5 row_ror:4 row_mask:0xf bank_mask:0xf
    s_nop 1
    v_max_f32_dpp v5, v5, v5 row_ror:8 row_mask:0xf bank_mask:0xf
    v_mov_b32 v9, v5
    s_nop 1
    v_permlane16_swap_b32 v5, v9
    v_max_f32 v5, v5, v9
    v_mov_b32 v9, v5
    s_nop 1
    v_permlane32_swap_b32 v5, v9
    v_max_f32 v5, v5, v9
    v_cvt_pk_bf16_f32 v5, v5, v5
    v_lshlrev_b32 v5, 16, v5
    v_mul_f32 v5, s57, v5
    v_sub_f32 v28, 0, v5
    v_mov_b32 v6, 0
    v_mov_b32 v16, 0
    v_mov_b32 v17, 0
    v_mov_b32 v18, 0
    v_mov_b32 v19, 0
    v_mov_b32 v20, 0
    v_mov_b32 v21, 0
    v_mov_b32 v22, 0
    v_mov_b32 v23, 0
    v_mov_b32 v24, 0
    v_mov_b32 v25, 0
    v_mov_b32 v26, 0
    v_mov_b32 v27, 0
    s_waitcnt lgkmcnt(0)
    v_lshlrev_b32 v10, 16, v29
    v_and_b32 v11, 0xffff0000, v29
    v_fma_f32 v10, v10, s57, v28
    v_fma_f32 v11, v11, s57, v28
    v_exp_f32 v10, v10
    v_exp_f32 v11, v11
    v_add_f32 v6, v6, v10
    v_add_f32 v6, v6, v11
    v_cvt_pk_bf16_f32 v9, v10, v11
    v_perm_b32 v14, v9, v9, v12
    v_perm_b32 v15, v9, v9, v13
    s_mov_b32 s58, 31
    s_mov_b32 s62, 0
    v_mov_b32 v30, 145984
    s_lshl_b32 s55, s3, 2
    v_add_u32 v7, s55, v30
    s_bitcmp1_b32 s62, 0
    s_cselect_b32 s28, 0x8100, 0
    s_bitcmp1_b32 s62, 1
    s_cselect_b32 s63, 0x20000, 0
    s_xor_b32 s28, s28, s63
    s_bitcmp1_b32 s62, 2
    s_cselect_b32 s63, 0xa4000, 0
    s_xor_b32 s28, s28, s63
    s_bitcmp1_b32 s62, 3
    s_cselect_b32 s63, 0x44000, 0
    s_xor_b32 s28, s28, s63
    s_bitcmp1_b32 s62, 4
    s_cselect_b32 s63, 0x100, 0
    s_xor_b32 s28, s28, s63
    s_xor_b32 s29, s28, 0x10000
    s_xor_b32 s30, s28, 0xa0000
    s_xor_b32 s31, s28, 0xb0000
L_v1:
    v_mov_b32_dpp v20, v14 quad_perm:[0,1,2,3] row_mask:0xf bank_mask:0x1
    v_mov_b32_dpp v21, v14 row_ror:4 row_mask:0xf bank_mask:0x2
    v_mov_b32_dpp v22, v14 row_ror:8 row_mask:0xf bank_mask:0x4
    v_mov_b32_dpp v23, v14 row_ror:12 row_mask:0xf bank_mask:0x8
    s_waitcnt vmcnt(4)
    buffer_load_dwordx4 v[60:63], v3, s[24:27], s31 offen offset:0 nt
    s_add_u32 s62, s62, 1
    s_bitcmp1_b32 s62, 0
    s_cselect_b32 s28, 0x8100, 0
    s_bitcmp1_b32 s62, 1
    s_cselect_b32 s63, 0x20000, 0
    s_xor_b32 s28, s28, s63
    s_bitcmp1_b32 s62, 2
    s_cselect_b32 s63, 0xa4000, 0
    s_xor_b32 s28, s28, s63
    s_bitcmp1_b32 s62, 3
    s_cselect_b32 s63, 0x44000, 0
    s_xor_b32 s28, s28, s63
    s_bitcmp1_b32 s62, 4
    s_cselect_b32 s63, 0x100, 0
    s_xor_b32 s28, s28, s63
    s_xor_b32 s29, s28, 0x10000
    s_xor_b32 s30, s28, 0xa0000
    s_xor_b32 s31, s28, 0xb0000
    v_mfma_f32_16x16x32_bf16 v[16:19], v[32:35], v[20:23], v[16:19]
    v_add_u32 v4, 0x100, v4
    ds_read_b32 v29, v4
    v_mov_b32_dpp v24, v14 row_ror:12 row_mask:0xf bank_mask:0x1
    v_mov_b32_dpp v25, v14 quad_perm:[0,1,2,3] row_mask:0xf bank_mask:0x2
    v_mov_b32_dpp v26, v14 row_ror:4 row_mask:0xf bank_mask:0x4
    v_mov_b32_dpp v27, v14 row_ror:8 row_mask:0xf bank_mask:0x8
    s_waitcnt vmcnt(4)
    buffer_load_dwordx4 v[32:35], v3, s[24:27], s28 offen offset:0 nt
    v_mfma_f32_16x16x32_bf16 v[16:19], v[36:39], v[24:27], v[16:19]
    v_mov_b32_dpp v20, v14 row_ror:8 row_mask:0xf bank_mask:0x1
    v_mov_b32_dpp v21, v14 row_ror:12 row_mask:0xf bank_mask:0x2
    v_mov_b32_dpp v22, v14 quad_perm:[0,1,2,3] row_mask:0xf bank_mask:0x4
    v_mov_b32_dpp v23, v14 row_ror:4 row_mask:0xf bank_mask:0x8
    s_waitcnt vmcnt(4)
    buffer_load_dwordx4 v[36:39], v3, s[24:27], s29 offen offset:512 nt
    v_mfma_f32_16x16x32_bf16 v[16:19], v[40:43], v[20:23], v[16:19]
    s_waitcnt lgkmcnt(0)
    v_lshlrev_b32 v10, 16, v29
    v_and_b32 v11, 0xffff0000, v29
    v_fma_f32 v10, v10, s57, v28
    v_fma_f32 v11, v11, s57, v28
    v_exp_f32 v10, v10
    v_exp_f32 v11, v11
    v_add_f32 v6, v6, v10
    v_add_f32 v6, v6, v11
    v_cvt_pk_bf16_f32 v9, v10, v11
    v_mov_b32_dpp v24, v14 row_ror:4 row_mask:0xf bank_mask:0x1
    v_mov_b32_dpp v25, v14 row_ror:8 row_mask:0xf bank_mask:0x2
    v_mov_b32_dpp v26, v14 row_ror:12 row_mask:0xf bank_mask:0x4
    v_mov_b32_dpp v27, v14 quad_perm:[0,1,2,3] row_mask:0xf bank_mask:0x8
    s_waitcnt vmcnt(4)
    buffer_load_dwordx4 v[40:43], v3, s[24:27], s28 offen offset:512 nt
    v_mfma_f32_16x16x32_bf16 v[16:19], v[44:47], v[24:27], v[16:19]
    v_mov_b32_dpp v20, v15 quad_perm:[0,1,2,3] row_mask:0xf bank_mask:0x1
    v_mov_b32_dpp v21, v15 row_ror:4 row_mask:0xf bank_mask:0x2
    v_mov_b32_dpp v22, v15 row_ror:8 row_mask:0xf bank_mask:0x4
    v_mov_b32_dpp v23, v15 row_ror:12 row_mask:0xf bank_mask:0x8
    s_waitcnt vmcnt(4)
    buffer_load_dwordx4 v[44:47], v3, s[24:27], s29 offen offset:0 nt
    v_mfma_f32_16x16x32_bf16 v[16:19], v[48:51], v[20:23], v[16:19]
    v_perm_b32 v14, v9, v9, v12
    v_mov_b32_dpp v24, v15 row_ror:12 row_mask:0xf bank_mask:0x1
    v_mov_b32_dpp v25, v15 quad_perm:[0,1,2,3] row_mask:0xf bank_mask:0x2
    v_mov_b32_dpp v26, v15 row_ror:4 row_mask:0xf bank_mask:0x4
    v_mov_b32_dpp v27, v15 row_ror:8 row_mask:0xf bank_mask:0x8
    s_waitcnt vmcnt(4)
    buffer_load_dwordx4 v[48:51], v3, s[24:27], s30 offen offset:0 nt
    v_mfma_f32_16x16x32_bf16 v[16:19], v[52:55], v[24:27], v[16:19]
    ds_read_b128 v[68:71], v30 offset:16
    v_mov_b32_dpp v20, v15 row_ror:8 row_mask:0xf bank_mask:0x1
    v_mov_b32_dpp v21, v15 row_ror:12 row_mask:0xf bank_mask:0x2
    v_mov_b32_dpp v22, v15 quad_perm:[0,1,2,3] row_mask:0xf bank_mask:0x4
    v_mov_b32_dpp v23, v15 row_ror:4 row_mask:0xf bank_mask:0x8
    s_waitcnt vmcnt(4)
    buffer_load_dwordx4 v[52:55], v3, s[24:27], s31 offen offset:512 nt
    v_mfma_f32_16x16x32_bf16 v[16:19], v[56:59], v[20:23], v[16:19]
    ds_read_b32 v8, v30
    v_mov_b32_dpp v24, v15 row_ror:4 row_mask:0xf bank_mask:0x1
    v_mov_b32_dpp v25, v15 row_ror:8 row_mask:0xf bank_mask:0x2
    v_mov_b32_dpp v26, v15 row_ror:12 row_mask:0xf bank_mask:0x4
    v_mov_b32_dpp v27, v15 quad_perm:[0,1,2,3] row_mask:0xf bank_mask:0x8
    s_waitcnt vmcnt(4)
    buffer_load_dwordx4 v[56:59], v3, s[24:27], s30 offen offset:512 nt
    v_mfma_f32_16x16x32_bf16 v[16:19], v[60:63], v[24:27], v[16:19]
    v_perm_b32 v15, v9, v9, v13
    s_branch L_vbot
L_v0:
    v_mov_b32_dpp v20, v14 quad_perm:[0,1,2,3] row_mask:0xf bank_mask:0x1
    v_mov_b32_dpp v21, v14 row_ror:4 row_mask:0xf bank_mask:0x2
    v_mov_b32_dpp v22, v14 row_ror:8 row_mask:0xf bank_mask:0x4
    v_mov_b32_dpp v23, v14 row_ror:12 row_mask:0xf bank_mask:0x8
    s_waitcnt vmcnt(3)
    buffer_load_dwordx4 v[60:63], v3, s[24:27], s31 offen offset:0 nt
    s_add_u32 s62, s62, 1
    s_bitcmp1_b32 s62, 0
    s_cselect_b32 s28, 0x8100, 0
    s_bitcmp1_b32 s62, 1
    s_cselect_b32 s63, 0x20000, 0
    s_xor_b32 s28, s28, s63
    s_bitcmp1_b32 s62, 2
    s_cselect_b32 s63, 0xa4000, 0
    s_xor_b32 s28, s28, s63
    s_bitcmp1_b32 s62, 3
    s_cselect_b32 s63, 0x44000, 0
    s_xor_b32 s28, s28, s63
    s_bitcmp1_b32 s62, 4
    s_cselect_b32 s63, 0x100, 0
    s_xor_b32 s28, s28, s63
    s_xor_b32 s29, s28, 0x10000
    s_xor_b32 s30, s28, 0xa0000
    s_xor_b32 s31, s28, 0xb0000
    v_mfma_f32_16x16x32_bf16 v[16:19], v[32:35], v[20:23], v[16:19]
    v_add_u32 v4, 0x100, v4
    ds_read_b32 v29, v4
    v_mov_b32_dpp v24, v14 row_ror:12 row_mask:0xf bank_mask:0x1
    v_mov_b32_dpp v25, v14 quad_perm:[0,1,2,3] row_mask:0xf bank_mask:0x2
    v_mov_b32_dpp v26, v14 row_ror:4 row_mask:0xf bank_mask:0x4
    v_mov_b32_dpp v27, v14 row_ror:8 row_mask:0xf bank_mask:0x8
    s_waitcnt vmcnt(3)
    buffer_load_dwordx4 v[32:35], v3, s[24:27], s28 offen offset:0 nt
    v_mfma_f32_16x16x32_bf16 v[16:19], v[36:39], v[24:27], v[16:19]
    v_mov_b32_dpp v20, v14 row_ror:8 row_mask:0xf bank_mask:0x1
    v_mov_b32_dpp v21, v14 row_ror:12 row_mask:0xf bank_mask:0x2
    v_mov_b32_dpp v22, v14 quad_perm:[0,1,2,3] row_mask:0xf bank_mask:0x4
    v_mov_b32_dpp v23, v14 row_ror:4 row_mask:0xf bank_mask:0x8
    s_waitcnt vmcnt(3)
    buffer_load_dwordx4 v[36:39], v3, s[24:27], s29 offen offset:512 nt
    v_mfma_f32_16x16x32_bf16 v[16:19], v[40:43], v[20:23], v[16:19]
    s_waitcnt lgkmcnt(0)
    v_lshlrev_b32 v10, 16, v29
    v_and_b32 v11, 0xffff0000, v29
    v_fma_f32 v10, v10, s57, v28
    v_fma_f32 v11, v11, s57, v28
    v_exp_f32 v10, v10
    v_exp_f32 v11, v11
    v_add_f32 v6, v6, v10
    v_add_f32 v6, v6, v11
    v_cvt_pk_bf16_f32 v9, v10, v11
    v_mov_b32_dpp v24, v14 row_ror:4 row_mask:0xf bank_mask:0x1
    v_mov_b32_dpp v25, v14 row_ror:8 row_mask:0xf bank_mask:0x2
    v_mov_b32_dpp v26, v14 row_ror:12 row_mask:0xf bank_mask:0x4
    v_mov_b32_dpp v27, v14 quad_perm:[0,1,2,3] row_mask:0xf bank_mask:0x8
    s_waitcnt vmcnt(3)
    buffer_load_dwordx4 v[40:43], v3, s[24:27], s28 offen offset:512 nt
    v_mfma_f32_16x16x32_bf16 v[16:19], v[44:47], v[24:27], v[16:19]
    v_mov_b32_dpp v20, v15 quad_perm:[0,1,2,3] row_mask:0xf bank_mask:0x1
    v_mov_b32_dpp v21, v15 row_ror:4 row_mask:0xf bank_mask:0x2
    v_mov_b32_dpp v22, v15 row_ror:8 row_mask:0xf bank_mask:0x4
    v_mov_b32_dpp v23, v15 row_ror:12 row_mask:0xf bank_mask:0x8
    s_waitcnt vmcnt(3)
    buffer_load_dwordx4 v[44:47], v3, s[24:27], s29 offen offset:0 nt
    v_mfma_f32_16x16x32_bf16 v[16:19], v[48:51], v[20:23], v[16:19]
    v_perm_b32 v14, v9, v9, v12
    v_mov_b32_dpp v24, v15 row_ror:12 row_mask:0xf bank_mask:0x1
    v_mov_b32_dpp v25, v15 quad_perm:[0,1,2,3] row_mask:0xf bank_mask:0x2
    v_mov_b32_dpp v26, v15 row_ror:4 row_mask:0xf bank_mask:0x4
    v_mov_b32_dpp v27, v15 row_ror:8 row_mask:0xf bank_mask:0x8
    s_waitcnt vmcnt(3)
    buffer_load_dwordx4 v[48:51], v3, s[24:27], s30 offen offset:0 nt
    v_mfma_f32_16x16x32_bf16 v[16:19], v[52:55], v[24:27], v[16:19]
    ds_read_b128 v[68:71], v30 offset:16
    v_mov_b32_dpp v20, v15 row_ror:8 row_mask:0xf bank_mask:0x1
    v_mov_b32_dpp v21, v15 row_ror:12 row_mask:0xf bank_mask:0x2
    v_mov_b32_dpp v22, v15 quad_perm:[0,1,2,3] row_mask:0xf bank_mask:0x4
    v_mov_b32_dpp v23, v15 row_ror:4 row_mask:0xf bank_mask:0x8
    s_waitcnt vmcnt(3)
    buffer_load_dwordx4 v[52:55], v3, s[24:27], s31 offen offset:512 nt
    v_mfma_f32_16x16x32_bf16 v[16:19], v[56:59], v[20:23], v[16:19]
    ds_read_b32 v8, v30
    v_mov_b32_dpp v24, v15 row_ror:4 row_mask:0xf bank_mask:0x1
    v_mov_b32_dpp v25, v15 row_ror:8 row_mask:0xf bank_mask:0x2
    v_mov_b32_dpp v26, v15 row_ror:12 row_mask:0xf bank_mask:0x4
    v_mov_b32_dpp v27, v15 quad_perm:[0,1,2,3] row_mask:0xf bank_mask:0x8
    s_waitcnt vmcnt(3)
    buffer_load_dwordx4 v[56:59], v3, s[24:27], s30 offen offset:512 nt
    v_mfma_f32_16x16x32_bf16 v[16:19], v[60:63], v[24:27], v[16:19]
    v_perm_b32 v15, v9, v9, v13
    s_branch L_vbot
L_v2:
    v_mov_b32_dpp v20, v14 quad_perm:[0,1,2,3] row_mask:0xf bank_mask:0x1
    v_mov_b32_dpp v21, v14 row_ror:4 row_mask:0xf bank_mask:0x2
    v_mov_b32_dpp v22, v14 row_ror:8 row_mask:0xf bank_mask:0x4
    v_mov_b32_dpp v23, v14 row_ror:12 row_mask:0xf bank_mask:0x8
    s_waitcnt vmcnt(5)
    buffer_load_dwordx4 v[60:63], v3, s[24:27], s31 offen offset:0 nt
    s_add_u32 s62, s62, 1
    s_bitcmp1_b32 s62, 0
    s_cselect_b32 s28, 0x8100, 0
    s_bitcmp1_b32 s62, 1
    s_cselect_b32 s63, 0x20000, 0
    s_xor_b32 s28, s28, s63
    s_bitcmp1_b32 s62, 2
    s_cselect_b32 s63, 0xa4000, 0
    s_xor_b32 s28, s28, s63
    s_bitcmp1_b32 s62, 3
    s_cselect_b32 s63, 0x44000, 0
    s_xor_b32 s28, s28, s63
    s_bitcmp1_b32 s62, 4
    s_cselect_b32 s63, 0x100, 0
    s_xor_b32 s28, s28, s63
    s_xor_b32 s29, s28, 0x10000
    s_xor_b32 s30, s28, 0xa0000
    s_xor_b32 s31, s28, 0xb0000
    v_mfma_f32_16x16x32_bf16 v[16:19], v[32:35], v[20:23], v[16:19]
    v_add_u32 v4, 0x100, v4
    ds_read_b32 v29, v4
    v_mov_b32_dpp v24, v14 row_ror:12 row_mask:0xf bank_mask:0x1
    v_mov_b32_dpp v25, v14 quad_perm:[0,1,2,3] row_mask:0xf bank_mask:0x2
    v_mov_b32_dpp v26, v14 row_ror:4 row_mask:0xf bank_mask:0x4
    v_mov_b32_dpp v27, v14 row_ror:8 row_mask:0xf bank_mask:0x8
    s_waitcnt vmcnt(5)
    buffer_load_dwordx4 v[32:35], v3, s[24:27], s28 offen offset:0 nt
    v_mfma_f32_16x16x32_bf16 v[16:19], v[36:39], v[24:27], v[16:19]
    v_mov_b32_dpp v20, v14 row_ror:8 row_mask:0xf bank_mask:0x1
    v_mov_b32_dpp v21, v14 row_ror:12 row_mask:0xf bank_mask:0x2
    v_mov_b32_dpp v22, v14 quad_perm:[0,1,2,3] row_mask:0xf bank_mask:0x4
    v_mov_b32_dpp v23, v14 row_ror:4 row_mask:0xf bank_mask:0x8
    s_waitcnt vmcnt(5)
    buffer_load_dwordx4 v[36:39], v3, s[24:27], s29 offen offset:512 nt
    v_mfma_f32_16x16x32_bf16 v[16:19], v[40:43], v[20:23], v[16:19]
    s_waitcnt lgkmcnt(0)
    v_lshlrev_b32 v10, 16, v29
    v_and_b32 v11, 0xffff0000, v29
    v_fma_f32 v10, v10, s57, v28
    v_fma_f32 v11, v11, s57, v28
    v_exp_f32 v10, v10
    v_exp_f32 v11, v11
    v_add_f32 v6, v6, v10
    v_add_f32 v6, v6, v11
    v_cvt_pk_bf16_f32 v9, v10, v11
    v_mov_b32_dpp v24, v14 row_ror:4 row_mask:0xf bank_mask:0x1
    v_mov_b32_dpp v25, v14 row_ror:8 row_mask:0xf bank_mask:0x2
    v_mov_b32_dpp v26, v14 row_ror:12 row_mask:0xf bank_mask:0x4
    v_mov_b32_dpp v27, v14 quad_perm:[0,1,2,3] row_mask:0xf bank_mask:0x8
    s_waitcnt vmcnt(5)
    buffer_load_dwordx4 v[40:43], v3, s[24:27], s28 offen offset:512 nt
    v_mfma_f32_16x16x32_bf16 v[16:19], v[44:47], v[24:27], v[16:19]
    v_mov_b32_dpp v20, v15 quad_perm:[0,1,2,3] row_mask:0xf bank_mask:0x1
    v_mov_b32_dpp v21, v15 row_ror:4 row_mask:0xf bank_mask:0x2
    v_mov_b32_dpp v22, v15 row_ror:8 row_mask:0xf bank_mask:0x4
    v_mov_b32_dpp v23, v15 row_ror:12 row_mask:0xf bank_mask:0x8
    s_waitcnt vmcnt(5)
    buffer_load_dwordx4 v[44:47], v3, s[24:27], s29 offen offset:0 nt
    v_mfma_f32_16x16x32_bf16 v[16:19], v[48:51], v[20:23], v[16:19]
    v_perm_b32 v14, v9, v9, v12
    v_mov_b32_dpp v24, v15 row_ror:12 row_mask:0xf bank_mask:0x1
    v_mov_b32_dpp v25, v15 quad_perm:[0,1,2,3] row_mask:0xf bank_mask:0x2
    v_mov_b32_dpp v26, v15 row_ror:4 row_mask:0xf bank_mask:0x4
    v_mov_b32_dpp v27, v15 row_ror:8 row_mask:0xf bank_mask:0x8
    s_waitcnt vmcnt(5)
    buffer_load_dwordx4 v[48:51], v3, s[24:27], s30 offen offset:0 nt
    v_mfma_f32_16x16x32_bf16 v[16:19], v[52:55], v[24:27], v[16:19]
    ds_read_b128 v[68:71], v30 offset:16
    v_mov_b32_dpp v20, v15 row_ror:8 row_mask:0xf bank_mask:0x1
    v_mov_b32_dpp v21, v15 row_ror:12 row_mask:0xf bank_mask:0x2
    v_mov_b32_dpp v22, v15 quad_perm:[0,1,2,3] row_mask:0xf bank_mask:0x4
    v_mov_b32_dpp v23, v15 row_ror:4 row_mask:0xf bank_mask:0x8
    s_waitcnt vmcnt(5)
    buffer_load_dwordx4 v[52:55], v3, s[24:27], s31 offen offset:512 nt
    v_mfma_f32_16x16x32_bf16 v[16:19], v[56:59], v[20:23], v[16:19]
    ds_read_b32 v8, v30
    v_mov_b32_dpp v24, v15 row_ror:4 row_mask:0xf bank_mask:0x1
    v_mov_b32_dpp v25, v15 row_ror:8 row_mask:0xf bank_mask:0x2
    v_mov_b32_dpp v26, v15 row_ror:12 row_mask:0xf bank_mask:0x4
    v_mov_b32_dpp v27, v15 quad_perm:[0,1,2,3] row_mask:0xf bank_mask:0x8
    s_waitcnt vmcnt(5)
    buffer_load_dwordx4 v[56:59], v3, s[24:27], s30 offen offset:512 nt
    v_mfma_f32_16x16x32_bf16 v[16:19], v[60:63], v[24:27], v[16:19]
    v_perm_b32 v15, v9, v9, v13
    s_branch L_vbot
L_v3:
    v_mov_b32_dpp v20, v14 quad_perm:[0,1,2,3] row_mask:0xf bank_mask:0x1
    v_mov_b32_dpp v21, v14 row_ror:4 row_mask:0xf bank_mask:0x2
    v_mov_b32_dpp v22, v14 row_ror:8 row_mask:0xf bank_mask:0x4
    v_mov_b32_dpp v23, v14 row_ror:12 row_mask:0xf bank_mask:0x8
    s_waitcnt vmcnt(6)
    buffer_load_dwordx4 v[60:63], v3, s[24:27], s31 offen offset:0 nt
    s_add_u32 s62, s62, 1
    s_bitcmp1_b32 s62, 0
    s_cselect_b32 s28, 0x8100, 0
    s_bitcmp1_b32 s62, 1
    s_cselect_b32 s63, 0x20000, 0
    s_xor_b32 s28, s28, s63
    s_bitcmp1_b32 s62, 2
    s_cselect_b32 s63, 0xa4000, 0
    s_xor_b32 s28, s28, s63
    s_bitcmp1_b32 s62, 3
    s_cselect_b32 s63, 0x44000, 0
    s_xor_b32 s28, s28, s63
    s_bitcmp1_b32 s62, 4
    s_cselect_b32 s63, 0x100, 0
    s_xor_b32 s28, s28, s63
    s_xor_b32 s29, s28, 0x10000
    s_xor_b32 s30, s28, 0xa0000
    s_xor_b32 s31, s28, 0xb0000
    v_mfma_f32_16x16x32_bf16 v[16:19], v[32:35], v[20:23], v[16:19]
    v_add_u32 v4, 0x100, v4
    ds_read_b32 v29, v4
    v_mov_b32_dpp v24, v14 row_ror:12 row_mask:0xf bank_mask:0x1
    v_mov_b32_dpp v25, v14 quad_perm:[0,1,2,3] row_mask:0xf bank_mask:0x2
    v_mov_b32_dpp v26, v14 row_ror:4 row_mask:0xf bank_mask:0x4
    v_mov_b32_dpp v27, v14 row_ror:8 row_mask:0xf bank_mask:0x8
    s_waitcnt vmcnt(6)
    buffer_load_dwordx4 v[32:35], v3, s[24:27], s28 offen offset:0 nt
    v_mfma_f32_16x16x32_bf16 v[16:19], v[36:39], v[24:27], v[16:19]
    v_mov_b32_dpp v20, v14 row_ror:8 row_mask:0xf bank_mask:0x1
    v_mov_b32_dpp v21, v14 row_ror:12 row_mask:0xf bank_mask:0x2
    v_mov_b32_dpp v22, v14 quad_perm:[0,1,2,3] row_mask:0xf bank_mask:0x4
    v_mov_b32_dpp v23, v14 row_ror:4 row_mask:0xf bank_mask:0x8
    s_waitcnt vmcnt(6)
    buffer_load_dwordx4 v[36:39], v3, s[24:27], s29 offen offset:512 nt
    v_mfma_f32_16x16x32_bf16 v[16:19], v[40:43], v[20:23], v[16:19]
    s_waitcnt lgkmcnt(0)
    v_lshlrev_b32 v10, 16, v29
    v_and_b32 v11, 0xffff0000, v29
    v_fma_f32 v10, v10, s57, v28
    v_fma_f32 v11, v11, s57, v28
    v_exp_f32 v10, v10
    v_exp_f32 v11, v11
    v_add_f32 v6, v6, v10
    v_add_f32 v6, v6, v11
    v_cvt_pk_bf16_f32 v9, v10, v11
    v_mov_b32_dpp v24, v14 row_ror:4 row_mask:0xf bank_mask:0x1
    v_mov_b32_dpp v25, v14 row_ror:8 row_mask:0xf bank_mask:0x2
    v_mov_b32_dpp v26, v14 row_ror:12 row_mask:0xf bank_mask:0x4
    v_mov_b32_dpp v27, v14 quad_perm:[0,1,2,3] row_mask:0xf bank_mask:0x8
    s_waitcnt vmcnt(6)
    buffer_load_dwordx4 v[40:43], v3, s[24:27], s28 offen offset:512 nt
    v_mfma_f32_16x16x32_bf16 v[16:19], v[44:47], v[24:27], v[16:19]
    v_mov_b32_dpp v20, v15 quad_perm:[0,1,2,3] row_mask:0xf bank_mask:0x1
    v_mov_b32_dpp v21, v15 row_ror:4 row_mask:0xf bank_mask:0x2
    v_mov_b32_dpp v22, v15 row_ror:8 row_mask:0xf bank_mask:0x4
    v_mov_b32_dpp v23, v15 row_ror:12 row_mask:0xf bank_mask:0x8
    s_waitcnt vmcnt(6)
    buffer_load_dwordx4 v[44:47], v3, s[24:27], s29 offen offset:0 nt
    v_mfma_f32_16x16x32_bf16 v[16:19], v[48:51], v[20:23], v[16:19]
    v_perm_b32 v14, v9, v9, v12
    v_mov_b32_dpp v24, v15 row_ror:12 row_mask:0xf bank_mask:0x1
    v_mov_b32_dpp v25, v15 quad_perm:[0,1,2,3] row_mask:0xf bank_mask:0x2
    v_mov_b32_dpp v26, v15 row_ror:4 row_mask:0xf bank_mask:0x4
    v_mov_b32_dpp v27, v15 row_ror:8 row_mask:0xf bank_mask:0x8
    s_waitcnt vmcnt(6)
    buffer_load_dwordx4 v[48:51], v3, s[24:27], s30 offen offset:0 nt
    v_mfma_f32_16x16x32_bf16 v[16:19], v[52:55], v[24:27], v[16:19]
    ds_read_b128 v[68:71], v30 offset:16
    v_mov_b32_dpp v20, v15 row_ror:8 row_mask:0xf bank_mask:0x1
    v_mov_b32_dpp v21, v15 row_ror:12 row_mask:0xf bank_mask:0x2
    v_mov_b32_dpp v22, v15 quad_perm:[0,1,2,3] row_mask:0xf bank_mask:0x4
    v_mov_b32_dpp v23, v15 row_ror:4 row_mask:0xf bank_mask:0x8
    s_waitcnt vmcnt(6)
    buffer_load_dwordx4 v[52:55], v3, s[24:27], s31 offen offset:512 nt
    v_mfma_f32_16x16x32_bf16 v[16:19], v[56:59], v[20:23], v[16:19]
    ds_read_b32 v8, v30
    v_mov_b32_dpp v24, v15 row_ror:4 row_mask:0xf bank_mask:0x1
    v_mov_b32_dpp v25, v15 row_ror:8 row_mask:0xf bank_mask:0x2
    v_mov_b32_dpp v26, v15 row_ror:12 row_mask:0xf bank_mask:0x4
    v_mov_b32_dpp v27, v15 quad_perm:[0,1,2,3] row_mask:0xf bank_mask:0x8
    s_waitcnt vmcnt(6)
    buffer_load_dwordx4 v[56:59], v3, s[24:27], s30 offen offset:512 nt
    v_mfma_f32_16x16x32_bf16 v[16:19], v[60:63], v[24:27], v[16:19]
    v_perm_b32 v15, v9, v9, v13
L_vbot:
    s_sub_u32 s58, s58, 1
    v_mov_b32 v31, s58
    s_waitcnt lgkmcnt(0)
    v_readfirstlane_b32 s55, v8
    ds_write_b32 v7, v31 offset:16
    v_min3_u32 v68, v68, v69, v70
    v_min_u32 v68, v68, v71
    s_cmp_eq_u32 s58, 1
    v_readfirstlane_b32 s50, v68
    s_cbranch_scc1 L_vlast
    s_cmp_le_u32 s50, s58
    s_addc_u32 s55, s55, 0
    s_cmp_eq_u32 s55, 1
    s_cbranch_scc1 L_v1
    s_cmp_eq_u32 s55, 0
    s_cbranch_scc1 L_v0
    s_cmp_eq_u32 s55, 2
    s_cbranch_scc1 L_v2
    s_branch L_v3
L_vlast:
    v_mov_b32_dpp v20, v14 quad_perm:[0,1,2,3] row_mask:0xf bank_mask:0x1
    v_mov_b32_dpp v21, v14 row_ror:4 row_mask:0xf bank_mask:0x2
    v_mov_b32_dpp v22, v14 row_ror:8 row_mask:0xf bank_mask:0x4
    v_mov_b32_dpp v23, v14 row_ror:12 row_mask:0xf bank_mask:0x8
    s_waitcnt vmcnt(6)
    buffer_load_dwordx4 v[60:63], v3, s[24:27], s31 offen offset:0 nt
    s_add_u32 s62, s62, 1
    s_bitcmp1_b32 s62, 0
    s_cselect_b32 s28, 0x8100, 0
    s_bitcmp1_b32 s62, 1
    s_cselect_b32 s63, 0x20000, 0
    s_xor_b32 s28, s28, s63
    s_bitcmp1_b32 s62, 2
    s_cselect_b32 s63, 0xa4000, 0
    s_xor_b32 s28, s28, s63
    s_bitcmp1_b32 s62, 3
    s_cselect_b32 s63, 0x44000, 0
    s_xor_b32 s28, s28, s63
    s_bitcmp1_b32 s62, 4
    s_cselect_b32 s63, 0x100, 0
    s_xor_b32 s28, s28, s63
    s_xor_b32 s29, s28, 0x10000
    s_xor_b32 s30, s28, 0xa0000
    s_xor_b32 s31, s28, 0xb0000
    v_mfma_f32_16x16x32_bf16 v[16:19], v[32:35], v[20:23], v[16:19]
    v_add_u32 v4, 0x100, v4
    ds_read_b32 v29, v4
    v_mov_b32_dpp v24, v14 row_ror:12 row_mask:0xf bank_mask:0x1
    v_mov_b32_dpp v25, v14 quad_perm:[0,1,2,3] row_mask:0xf bank_mask:0x2
    v_mov_b32_dpp v26, v14 row_ror:4 row_mask:0xf bank_mask:0x4
    v_mov_b32_dpp v27, v14 row_ror:8 row_mask:0xf bank_mask:0x8
    s_waitcnt vmcnt(6)
    buffer_load_dwordx4 v[32:35], v3, s[24:27], s28 offen offset:0 nt
    v_mfma_f32_16x16x32_bf16 v[16:19], v[36:39], v[24:27], v[16:19]
    v_mov_b32_dpp v20, v14 row_ror:8 row_mask:0xf bank_mask:0x1
    v_mov_b32_dpp v21, v14 row_ror:12 row_mask:0xf bank_mask:0x2
    v_mov_b32_dpp v22, v14 quad_perm:[0,1,2,3] row_mask:0xf bank_mask:0x4
    v_mov_b32_dpp v23, v14 row_ror:4 row_mask:0xf bank_mask:0x8
    s_waitcnt vmcnt(6)
    buffer_load_dwordx4 v[36:39], v3, s[24:27], s29 offen offset:512 nt
    v_mfma_f32_16x16x32_bf16 v[16:19], v[40:43], v[20:23], v[16:19]
    s_waitcnt lgkmcnt(0)
    v_lshlrev_b32 v10, 16, v29
    v_and_b32 v11, 0xffff0000, v29
    v_fma_f32 v10, v10, s57, v28
    v_fma_f32 v11, v11, s57, v28
    v_exp_f32 v10, v10
    v_exp_f32 v11, v11
    v_add_f32 v6, v6, v10
    v_add_f32 v6, v6, v11
    v_cvt_pk_bf16_f32 v9, v10, v11
    v_mov_b32_dpp v24, v14 row_ror:4 row_mask:0xf bank_mask:0x1
    v_mov_b32_dpp v25, v14 row_ror:8 row_mask:0xf bank_mask:0x2
    v_mov_b32_dpp v26, v14 row_ror:12 row_mask:0xf bank_mask:0x4
    v_mov_b32_dpp v27, v14 quad_perm:[0,1,2,3] row_mask:0xf bank_mask:0x8
    s_waitcnt vmcnt(6)
    buffer_load_dwordx4 v[40:43], v3, s[24:27], s28 offen offset:512 nt
    v_mfma_f32_16x16x32_bf16 v[16:19], v[44:47], v[24:27], v[16:19]
    v_mov_b32_dpp v20, v15 quad_perm:[0,1,2,3] row_mask:0xf bank_mask:0x1
    v_mov_b32_dpp v21, v15 row_ror:4 row_mask:0xf bank_mask:0x2
    v_mov_b32_dpp v22, v15 row_ror:8 row_mask:0xf bank_mask:0x4
    v_mov_b32_dpp v23, v15 row_ror:12 row_mask:0xf bank_mask:0x8
    s_waitcnt vmcnt(6)
    buffer_load_dwordx4 v[44:47], v3, s[24:27], s29 offen offset:0 nt
    v_mfma_f32_16x16x32_bf16 v[16:19], v[48:51], v[20:23], v[16:19]
    v_perm_b32 v14, v9, v9, v12
    v_mov_b32_dpp v24, v15 row_ror:12 row_mask:0xf bank_mask:0x1
    v_mov_b32_dpp v25, v15 quad_perm:[0,1,2,3] row_mask:0xf bank_mask:0x2
    v_mov_b32_dpp v26, v15 row_ror:4 row_mask:0xf bank_mask:0x4
    v_mov_b32_dpp v27, v15 row_ror:8 row_mask:0xf bank_mask:0x8
    s_waitcnt vmcnt(6)
    buffer_load_dwordx4 v[48:51], v3, s[24:27], s30 offen offset:0 nt
    v_mfma_f32_16x16x32_bf16 v[16:19], v[52:55], v[24:27], v[16:19]
    v_mov_b32_dpp v20, v15 row_ror:8 row_mask:0xf bank_mask:0x1
    v_mov_b32_dpp v21, v15 row_ror:12 row_mask:0xf bank_mask:0x2
    v_mov_b32_dpp v22, v15 quad_perm:[0,1,2,3] row_mask:0xf bank_mask:0x4
    v_mov_b32_dpp v23, v15 row_ror:4 row_mask:0xf bank_mask:0x8
    s_waitcnt vmcnt(6)
    buffer_load_dwordx4 v[52:55], v3, s[24:27], s31 offen offset:512 nt
    v_mfma_f32_16x16x32_bf16 v[16:19], v[56:59], v[20:23], v[16:19]
    v_mov_b32_dpp v24, v15 row_ror:4 row_mask:0xf bank_mask:0x1
    v_mov_b32_dpp v25, v15 row_ror:8 row_mask:0xf bank_mask:0x2
    v_mov_b32_dpp v26, v15 row_ror:12 row_mask:0xf bank_mask:0x4
    v_mov_b32_dpp v27, v15 quad_perm:[0,1,2,3] row_mask:0xf bank_mask:0x8
    s_waitcnt vmcnt(6)
    buffer_load_dwordx4 v[56:59], v3, s[24:27], s30 offen offset:512 nt
    v_mfma_f32_16x16x32_bf16 v[16:19], v[60:63], v[24:27], v[16:19]
    v_perm_b32 v15, v9, v9, v13
    s_sub_u32 s58, s58, 1
    s_cmp_lg_u32 s58, 0
    s_cbranch_scc1 L_vlast
    v_mov_b32_dpp v20, v14 quad_perm:[0,1,2,3] row_mask:0xf bank_mask:0x1
    v_mov_b32_dpp v21, v14 row_ror:4 row_mask:0xf bank_mask:0x2
    v_mov_b32_dpp v22, v14 row_ror:8 row_mask:0xf bank_mask:0x4
    v_mov_b32_dpp v23, v14 row_ror:12 row_mask:0xf bank_mask:0x8
    s_waitcnt vmcnt(6)
    buffer_load_dwordx4 v[60:63], v3, s[24:27], s31 offen offset:0 nt
    s_add_u32 s62, s62, 1
    s_bitcmp1_b32 s62, 0
    s_cselect_b32 s28, 0x8100, 0
    s_bitcmp1_b32 s62, 1
    s_cselect_b32 s63, 0x20000, 0
    s_xor_b32 s28, s28, s63
    s_bitcmp1_b32 s62, 2
    s_cselect_b32 s63, 0xa4000, 0
    s_xor_b32 s28, s28, s63
    s_bitcmp1_b32 s62, 3
    s_cselect_b32 s63, 0x44000, 0
    s_xor_b32 s28, s28, s63
    s_bitcmp1_b32 s62, 4
    s_cselect_b32 s63, 0x100, 0
    s_xor_b32 s28, s28, s63
    s_xor_b32 s29, s28, 0x10000
    s_xor_b32 s30, s28, 0xa0000
    s_xor_b32 s31, s28, 0xb0000
    v_mfma_f32_16x16x32_bf16 v[16:19], v[32:35], v[20:23], v[16:19]
    s_nop 1
    v_add_f32_dpp v6, v6, v6 row_ror:4 row_mask:0xf bank_mask:0xf
    s_nop 1
    v_add_f32_dpp v6, v6, v6 row_ror:8 row_mask:0xf bank_mask:0xf
    v_mov_b32 v9, v6
    s_nop 1
    v_permlane16_swap_b32 v6, v9
    v_add_f32 v6, v6, v9
    v_mov_b32 v9, v6
    s_nop 1
    v_permlane32_swap_b32 v6, v9
    v_add_f32 v6, v6, v9
    v_and_b32 v30, 1, v1
    v_lshlrev_b32 v30, 5, v30
    v_add_u32 v30, 145920, v30
    s_lshl_b32 s55, s3, 3
    v_add_u32 v31, s55, v30
    v_mov_b32 v10, v5
    v_mov_b32 v11, v6
    ds_write_b64 v31, v[10:11]
    s_waitcnt lgkmcnt(0)
    s_barrier
    ds_read_b128 v[68:71], v30
    ds_read_b128 v[72:75], v30 offset:16
    s_lshl_b32 s55, s3, 10
    s_add_u32 s55, s55, 141312
    v_lshlrev_b32 v31, 4, v1
    v_add_u32 v31, s55, v31
    s_waitcnt lgkmcnt(0)
    v_max3_f32 v9, v68, v70, v72
    v_max_f32 v9, v9, v74
    v_sub_f32 v68, v68, v9
    v_sub_f32 v70, v70, v9
    v_sub_f32 v72, v72, v9
    v_sub_f32 v74, v74, v9
    v_sub_f32 v10, v5, v9
    v_exp_f32 v68, v68
    v_exp_f32 v70, v70
    v_exp_f32 v72, v72
    v_exp_f32 v74, v74
    v_exp_f32 v10, v10
    v_mul_f32 v11, v68, v69
    v_fmac_f32 v11, v70, v71
    v_fmac_f32 v11, v72, v73
    v_fmac_f32 v11, v74, v75
    v_rcp_f32 v11, v11
    s_nop 0
    v_mul_f32 v10, v10, v11
    v_mov_b32 v11, v10
    v_mov_b32_dpp v24, v14 row_ror:12 row_mask:0xf bank_mask:0x1
    v_mov_b32_dpp v25, v14 quad_perm:[0,1,2,3] row_mask:0xf bank_mask:0x2
    v_mov_b32_dpp v26, v14 row_ror:4 row_mask:0xf bank_mask:0x4
    v_mov_b32_dpp v27, v14 row_ror:8 row_mask:0xf bank_mask:0x8
    s_waitcnt vmcnt(6)
    s_nop 0
    v_mfma_f32_16x16x32_bf16 v[16:19], v[36:39], v[24:27], v[16:19]
    v_mov_b32_dpp v20, v14 row_ror:8 row_mask:0xf bank_mask:0x1
    v_mov_b32_dpp v21, v14 row_ror:12 row_mask:0xf bank_mask:0x2
    v_mov_b32_dpp v22, v14 quad_perm:[0,1,2,3] row_mask:0xf bank_mask:0x4
    v_mov_b32_dpp v23, v14 row_ror:4 row_mask:0xf bank_mask:0x8
    s_waitcnt vmcnt(5)
    s_nop 0
    v_mfma_f32_16x16x32_bf16 v[16:19], v[40:43], v[20:23], v[16:19]
    v_mov_b32_dpp v24, v14 row_ror:4 row_mask:0xf bank_mask:0x1
    v_mov_b32_dpp v25, v14 row_ror:8 row_mask:0xf bank_mask:0x2
    v_mov_b32_dpp v26, v14 row_ror:12 row_mask:0xf bank_mask:0x4
    v_mov_b32_dpp v27, v14 quad_perm:[0,1,2,3] row_mask:0xf bank_mask:0x8
    s_waitcnt vmcnt(4)
    s_nop 0
    v_mfma_f32_16x16x32_bf16 v[16:19], v[44:47], v[24:27], v[16:19]
    v_mov_b32_dpp v20, v15 quad_perm:[0,1,2,3] row_mask:0xf bank_mask:0x1
    v_mov_b32_dpp v21, v15 row_ror:4 row_mask:0xf bank_mask:0x2
    v_mov_b32_dpp v22, v15 row_ror:8 row_mask:0xf bank_mask:0x4
    v_mov_b32_dpp v23, v15 row_ror:12 row_mask:0xf bank_mask:0x8
    s_waitcnt vmcnt(3)
    s_nop 0
    v_mfma_f32_16x16x32_bf16 v[16:19], v[48:51], v[20:23], v[16:19]
    v_mov_b32_dpp v24, v15 row_ror:12 row_mask:0xf bank_mask:0x1
    v_mov_b32_dpp v25, v15 quad_perm:[0,1,2,3] row_mask:0xf bank_mask:0x2
    v_mov_b32_dpp v26, v15 row_ror:4 row_mask:0xf bank_mask:0x4
    v_mov_b32_dpp v27, v15 row_ror:8 row_mask:0xf bank_mask:0x8
    s_waitcnt vmcnt(2)
    s_nop 0
    v_mfma_f32_16x16x32_bf16 v[16:19], v[52:55], v[24:27], v[16:19]
    v_mov_b32_dpp v20, v15 row_ror:8 row_mask:0xf bank_mask:0x1
    v_mov_b32_dpp v21, v15 row_ror:12 row_mask:0xf bank_mask:0x2
    v_mov_b32_dpp v22, v15 quad_perm:[0,1,2,3] row_mask:0xf bank_mask:0x4
    v_mov_b32_dpp v23, v15 row_ror:4 row_mask:0xf bank_mask:0x8
    s_waitcnt vmcnt(1)
    s_nop 0
    v_mfma_f32_16x16x32_bf16 v[16:19], v[56:59], v[20:23], v[16:19]
    v_mov_b32_dpp v24, v15 row_ror:4 row_mask:0xf bank_mask:0x1
    v_mov_b32_dpp v25, v15 row_ror:8 row_mask:0xf bank_mask:0x2
    v_mov_b32_dpp v26, v15 row_ror:12 row_mask:0xf bank_mask:0x4
    v_mov_b32_dpp v27, v15 quad_perm:[0,1,2,3] row_mask:0xf bank_mask:0x8
    s_waitcnt vmcnt(0)
    s_nop 0
    v_mfma_f32_16x16x32_bf16 v[16:19], v[60:63], v[24:27], v[16:19]
    s_nop 7
    v_pk_mul_f32 v[16:17], v[16:17], v[10:11]
    v_pk_mul_f32 v[18:19], v[18:19], v[10:11]
    ds_write_b128 v31, v[16:19]
    s_waitcnt lgkmcnt(0)
    s_barrier
    s_setprio 0
    s_sub_u32 s51, s48, s49
    s_and_b32 s50, s51, 3
    s_cbranch_scc1 L_sdone
    s_cmp_eq_u32 s3, 3
    s_cbranch_scc1 L_sdone
    s_bfe_u32 s51, s51, 0x20002
    s_mul_i32 s52, s51, 3
    s_add_u32 s52, s52, s3
    s_lshl_b32 s53, s52, 4
    v_and_b32 v0, 15, v1
    v_add_u32 v0, s53, v0
    v_lshrrev_b32 v9, 4, v1
    v_mul_u32_u24 v9, 3072, v9
    v_lshl_add_u32 v10, v0, 4, v9
    v_lshlrev_b32 v3, 2, v0
    v_lshlrev_b32 v6, 1, v0
    s_add_u32 s59, s59, 0x9e3779b9
    s_mul_i32 s50, s49, 49152
    s_add_u32 s40, s18, s50
    s_addc_u32 s41, s19, 0
    s_and_b32 s41, s41, 0xffff
    s_mov_b32 s42, 49152
    s_mov_b32 s43, 0x20000
    s_mul_i32 s50, s49, 1152
    s_add_u32 s44, s14, s50
    s_addc_u32 s45, s15, 0
    s_and_b32 s45, s45, 0xffff
    s_mov_b32 s46, 1152
    s_mov_b32 s47, 0x20000
    s_lshl_b32 s50, s49, 2
    s_add_u32 s50, s50, 983040
    v_mov_b32 v7, s50
    v_mov_b32 v8, s59
    s_mov_b32 s53, 12288
    s_mov_b32 s54, 24576
    s_mov_b32 s55, 36864
    s_mov_b32 s58, 0x800000
    s_barrier
L_poll:
    buffer_load_dwordx4 v[32:35], v10, s[40:43], 0 offen sc1
    buffer_load_dwordx4 v[36:39], v10, s[40:43], s53 offen sc1
    buffer_load_dwordx4 v[40:43], v10, s[40:43], s54 offen sc1
    buffer_load_dwordx4 v[44:47], v10, s[40:43], s55 offen sc1
    s_sub_u32 s58, s58, 1
    s_waitcnt vmcnt(2)
    v_xor_b32 v35, s59, v35
    v_xor_b32 v39, s59, v39
    v_pk_add_f32 v[32:33], v[32:33], v[36:37]
    v_add_f32 v34, v34, v38
    s_waitcnt vmcnt(0)
    v_xor_b32 v43, s59, v43
    v_xor_b32 v47, s59, v47
    v_or3_b32 v35, v35, v39, v43
    v_or_b32 v35, v35, v47
    v_cmp_ne_u32 vcc, 0, v35
    v_pk_add_f32 v[40:41], v[40:41], v[44:45]
    v_add_f32 v42, v42, v46
    v_pk_add_f32 v[32:33], v[32:33], v[40:41]
    v_add_f32 v34, v34, v42
    s_cbranch_scc1 L_pollsum
    s_cbranch_vccnz L_poll
L_pollsum:
    v_mov_b32 v36, v32
    v_mov_b32 v37, v33
    v_mov_b32 v38, v34
    v_permlane16_swap_b32 v32, v36
    v_permlane16_swap_b32 v33, v37
    v_permlane16_swap_b32 v34, v38
    v_pk_add_f32 v[32:33], v[32:33], v[36:37]
    v_add_f32 v34, v34, v38
    v_mov_b32 v36, v32
    v_mov_b32 v37, v33
    v_mov_b32 v38, v34
    v_permlane32_swap_b32 v32, v36
    v_permlane32_swap_b32 v33, v37
    v_permlane32_swap_b32 v34, v38
    v_pk_add_f32 v[32:33], v[32:33], v[36:37]
    v_add_f32 v34, v34, v38
    s_mov_b64 exec, 0xffff
    v_cvt_pk_bf16_f32 v4, v32, v33
    v_cvt_pk_bf16_f32 v5, v34, v34
    buffer_store_dword v4, v3, s[44:47], 0 offen
    buffer_store_short v5, v6, s[44:47], 0 offen offset:768
    s_cmp_lg_u32 s52, 0
    s_cbranch_scc1 L_sdone
    s_mov_b64 exec, 1
    global_store_dword v7, v8, s[18:19] sc1
L_sdone:
    s_endpgm
L_qdone:
    s_load_dword s63, s[18:19], 983040
    v_mov_b32 v3, 145984
    v_mov_b32 v8, 1
    v_mov_b32 v9, 99
    ds_write2_b32 v3, v8, v9 offset0:0 offset1:4
    ds_write2_b32 v3, v9, v9 offset0:5 offset1:6
    ds_write_b32 v3, v9 offset:28
    s_waitcnt lgkmcnt(0)
    s_barrier
    v_bfe_u32 v8, v1, 5, 1
    v_lshlrev_b32 v8, 7, v8
    v_bfe_u32 v9, v1, 4, 1
    v_lshl_add_u32 v8, v9, 3, v8
    v_bfe_u32 v9, v1, 3, 1
    v_lshl_add_u32 v8, v9, 4, v8
    s_lshl_b32 s50, s61, 5
    v_add_u32 v8, s50, v8
    v_mul_u32_u24 v2, 1152, v8
    v_and_b32 v9, 7, v1
    v_lshl_add_u32 v2, v9, 4, v2
    s_mul_i32 s52, s61, 24576
    s_movk_i32 s50, 0
    buffer_load_dwordx4 v[64:67], v2, s[32:35], s50 offen nt
    s_movk_i32 s50, 1152
    buffer_load_dwordx4 v[68:71], v2, s[32:35], s50 offen nt
    s_waitcnt vmcnt(1)
    s_movk_i32 s50, 128
    buffer_load_dwordx4 v[72:75], v2, s[32:35], s50 offen nt
    s_waitcnt vmcnt(1)
    s_movk_i32 s50, 1280
    buffer_load_dwordx4 v[76:79], v2, s[32:35], s50 offen nt
    s_waitcnt vmcnt(1)
    s_movk_i32 s50, 256
    buffer_load_dwordx4 v[80:83], v2, s[32:35], s50 offen nt
    s_waitcnt vmcnt(1)
    s_movk_i32 s50, 1408
    buffer_load_dwordx4 v[84:87], v2, s[32:35], s50 offen nt
    s_waitcnt vmcnt(1)
    s_movk_i32 s50, 384
    buffer_load_dwordx4 v[88:91], v2, s[32:35], s50 offen nt
    s_waitcnt vmcnt(1)
    s_movk_i32 s50, 1536
    buffer_load_dwordx4 v[92:95], v2, s[32:35], s50 offen nt
    s_waitcnt vmcnt(1)
    s_movk_i32 s50, 512
    buffer_load_dwordx4 v[96:99], v2, s[32:35], s50 offen nt
    s_waitcnt vmcnt(1)
    s_movk_i32 s50, 1664
    buffer_load_dwordx4 v[100:103], v2, s[32:35], s50 offen nt
    s_waitcnt vmcnt(1)
    s_movk_i32 s50, 640
    buffer_load_dwordx4 v[104:107], v2, s[32:35], s50 offen nt
    s_waitcnt vmcnt(1)
    s_movk_i32 s50, 1792
    buffer_load_dwordx4 v[108:111], v2, s[32:35], s50 offen nt
    s_waitcnt vmcnt(1)
    s_movk_i32 s50, 768
    buffer_load_dwordx4 v[112:115], v2, s[32:35], s50 offen nt
    s_waitcnt vmcnt(1)
    s_movk_i32 s50, 1920
    buffer_load_dwordx4 v[116:119], v2, s[32:35], s50 offen nt
    s_waitcnt vmcnt(1)
    s_movk_i32 s50, 896
    buffer_load_dwordx4 v[120:123], v2, s[32:35], s50 offen nt
    s_waitcnt vmcnt(1)
    s_movk_i32 s50, 2048
    buffer_load_dwordx4 v[124:127], v2, s[32:35], s50 offen nt
    s_waitcnt vmcnt(1)
    s_movk_i32 s50, 1024
    buffer_load_dwordx4 v[128:131], v2, s[32:35], s50 offen nt
    s_waitcnt vmcnt(1)
    s_movk_i32 s50, 2176
    buffer_load_dwordx4 v[132:135], v2, s[32:35], s50 offen nt
    s_waitcnt vmcnt(1)
    s_movk_i32 s50, 2304
    buffer_load_dwordx4 v[136:139], v2, s[32:35], s50 offen nt
    s_waitcnt vmcnt(1)
    s_movk_i32 s50, 3456
    buffer_load_dwordx4 v[140:143], v2, s[32:35], s50 offen nt
    s_waitcnt vmcnt(1)
    s_movk_i32 s50, 2432
    buffer_load_dwordx4 v[144:147], v2, s[32:35], s50 offen nt
    s_waitcnt vmcnt(1)
    s_movk_i32 s50, 3584
    buffer_load_dwordx4 v[148:151], v2, s[32:35], s50 offen nt
    s_waitcnt vmcnt(1)
    s_movk_i32 s50, 2560
    buffer_load_dwordx4 v[152:155], v2, s[32:35], s50 offen nt
    s_waitcnt vmcnt(1)
    s_movk_i32 s50, 3712
    buffer_load_dwordx4 v[156:159], v2, s[32:35], s50 offen nt
    s_waitcnt vmcnt(1)
    s_movk_i32 s50, 2688
    buffer_load_dwordx4 v[160:163], v2, s[32:35], s50 offen nt
    s_waitcnt vmcnt(1)
    s_movk_i32 s50, 3840
    buffer_load_dwordx4 v[164:167], v2, s[32:35], s50 offen nt
    s_waitcnt vmcnt(1)
    s_movk_i32 s50, 2816
    buffer_load_dwordx4 v[168:171], v2, s[32:35], s50 offen nt
    s_waitcnt vmcnt(1)
    s_movk_i32 s50, 3968
    buffer_load_dwordx4 v[172:175], v2, s[32:35], s50 offen nt
    s_waitcnt vmcnt(1)
    s_movk_i32 s50, 2944
    buffer_load_dwordx4 v[176:179], v2, s[32:35], s50 offen nt
    s_waitcnt vmcnt(1)
    s_movk_i32 s50, 4096
    buffer_load_dwordx4 v[180:183], v2, s[32:35], s50 offen nt
    s_waitcnt vmcnt(1)
    s_movk_i32 s50, 3072
    buffer_load_dwordx4 v[184:187], v2, s[32:35], s50 offen nt
    s_waitcnt vmcnt(1)
    s_movk_i32 s50, 4224
    buffer_load_dwordx4 v[188:191], v2, s[32:35], s50 offen nt
    s_waitcnt vmcnt(1)
    s_movk_i32 s50, 3200
    buffer_load_dwordx4 v[192:195], v2, s[32:35], s50 offen nt
    s_waitcnt vmcnt(1)
    s_movk_i32 s50, 4352
    buffer_load_dwordx4 v[196:199], v2, s[32:35], s50 offen nt
    s_waitcnt vmcnt(1)
    s_movk_i32 s50, 3328
    buffer_load_dwordx4 v[200:203], v2, s[32:35], s50 offen nt
    s_waitcnt vmcnt(1)
    s_movk_i32 s50, 4480
    buffer_load_dwordx4 v[204:207], v2, s[32:35], s50 offen nt
    s_waitcnt vmcnt(1)
    s_movk_i32 s50, 4608
    buffer_load_dwordx4 v[208:211], v2, s[32:35], s50 offen nt
    s_waitcnt vmcnt(1)
    s_movk_i32 s50, 5760
    buffer_load_dwordx4 v[212:215], v2, s[32:35], s50 offen nt
    s_waitcnt vmcnt(1)
    s_movk_i32 s50, 4736
    buffer_load_dwordx4 v[216:219], v2, s[32:35], s50 offen nt
    s_waitcnt vmcnt(1)
    s_movk_i32 s50, 5888
    buffer_load_dwordx4 v[220:223], v2, s[32:35], s50 offen nt
    s_waitcnt vmcnt(1)
    s_movk_i32 s50, 4864
    buffer_load_dwordx4 v[224:227], v2, s[32:35], s50 offen nt
    s_waitcnt vmcnt(1)
    s_movk_i32 s50, 6016
    buffer_load_dwordx4 v[228:231], v2, s[32:35], s50 offen nt
    s_waitcnt vmcnt(1)
    s_movk_i32 s50, 4992
    buffer_load_dwordx4 v[232:235], v2, s[32:35], s50 offen nt
    s_waitcnt vmcnt(1)
    s_movk_i32 s50, 6144
    buffer_load_dwordx4 v[236:239], v2, s[32:35], s50 offen nt
    s_waitcnt vmcnt(1)
    s_movk_i32 s50, 5120
    buffer_load_dwordx4 v[240:243], v2, s[32:35], s50 offen nt
    s_waitcnt vmcnt(1)
    s_movk_i32 s50, 6272
    buffer_load_dwordx4 v[244:247], v2, s[32:35], s50 offen nt
    s_waitcnt vmcnt(1)
    s_movk_i32 s50, 5248
    buffer_load_dwordx4 v[248:251], v2, s[32:35], s50 offen nt
    s_waitcnt vmcnt(1)
    s_movk_i32 s50, 6400
    buffer_load_dwordx4 v[252:255], v2, s[32:35], s50 offen nt
    s_waitcnt vmcnt(1)
    s_movk_i32 s50, 5376
    s_add_u32 m0, s52, 0
    s_nop 0
    buffer_load_dwordx4 v2, s[32:35], s50 offen nt lds
    s_waitcnt vmcnt(1)
    s_movk_i32 s50, 6528
    s_add_u32 m0, s52, 1024
    s_nop 0
    buffer_load_dwordx4 v2, s[32:35], s50 offen nt lds
    s_waitcnt vmcnt(1)
    s_movk_i32 s50, 5504
    s_add_u32 m0, s52, 2048
    s_nop 0
    buffer_load_dwordx4 v2, s[32:35], s50 offen nt lds
    s_waitcnt vmcnt(1)
    s_movk_i32 s50, 6656
    s_add_u32 m0, s52, 3072
    s_nop 0
    buffer_load_dwordx4 v2, s[32:35], s50 offen nt lds
    s_waitcnt vmcnt(1)
    s_movk_i32 s50, 5632
    s_add_u32 m0, s52, 4096
    s_nop 0
    buffer_load_dwordx4 v2, s[32:35], s50 offen nt lds
    s_waitcnt vmcnt(1)
    s_movk_i32 s50, 6784
    s_add_u32 m0, s52, 5120
    s_nop 0
    buffer_load_dwordx4 v2, s[32:35], s50 offen nt lds
    s_waitcnt vmcnt(1)
    s_movk_i32 s50, 6912
    s_add_u32 m0, s52, 6144
    s_nop 0
    buffer_load_dwordx4 v2, s[32:35], s50 offen nt lds
    s_waitcnt vmcnt(1)
    s_movk_i32 s50, 8064
    s_add_u32 m0, s52, 7168
    s_nop 0
    buffer_load_dwordx4 v2, s[32:35], s50 offen nt lds
    s_waitcnt vmcnt(1)
    s_movk_i32 s50, 7040
    s_add_u32 m0, s52, 8192
    s_nop 0
    buffer_load_dwordx4 v2, s[32:35], s50 offen nt lds
    s_waitcnt vmcnt(1)
    s_movk_i32 s50, 8192
    s_add_u32 m0, s52, 9216
    s_nop 0
    buffer_load_dwordx4 v2, s[32:35], s50 offen nt lds
    s_waitcnt vmcnt(1)
    s_movk_i32 s50, 7168
    s_add_u32 m0, s52, 10240
    s_nop 0
    buffer_load_dwordx4 v2, s[32:35], s50 offen nt lds
    s_waitcnt vmcnt(1)
    s_movk_i32 s50, 8320
    s_add_u32 m0, s52, 11264
    s_nop 0
    buffer_load_dwordx4 v2, s[32:35], s50 offen nt lds
    s_waitcnt vmcnt(1)
    s_movk_i32 s50, 7296
    s_add_u32 m0, s52, 12288
    s_nop 0
    buffer_load_dwordx4 v2, s[32:35], s50 offen nt lds
    s_waitcnt vmcnt(1)
    s_movk_i32 s50, 8448
    s_add_u32 m0, s52, 13312
    s_nop 0
    buffer_load_dwordx4 v2, s[32:35], s50 offen nt lds
    s_waitcnt vmcnt(1)
    s_movk_i32 s50, 7424
    s_add_u32 m0, s52, 14336
    s_nop 0
    buffer_load_dwordx4 v2, s[32:35], s50 offen nt lds
    s_waitcnt vmcnt(1)
    s_movk_i32 s50, 8576
    s_add_u32 m0, s52, 15360
    s_nop 0
    buffer_load_dwordx4 v2, s[32:35], s50 offen nt lds
    s_waitcnt vmcnt(1)
    s_movk_i32 s50, 7552
    s_add_u32 m0, s52, 16384
    s_nop 0
    buffer_load_dwordx4 v2, s[32:35], s50 offen nt lds
    s_waitcnt vmcnt(1)
    s_movk_i32 s50, 8704
    s_add_u32 m0, s52, 17408
    s_nop 0
    buffer_load_dwordx4 v2, s[32:35], s50 offen nt lds
    s_waitcnt vmcnt(1)
    s_movk_i32 s50, 7680
    s_add_u32 m0, s52, 18432
    s_nop 0
    buffer_load_dwordx4 v2, s[32:35], s50 offen nt lds
    s_waitcnt vmcnt(1)
    s_movk_i32 s50, 8832
    s_add_u32 m0, s52, 19456
    s_nop 0
    buffer_load_dwordx4 v2, s[32:35], s50 offen nt lds
    s_waitcnt vmcnt(1)
    s_movk_i32 s50, 7808
    s_add_u32 m0, s52, 20480
    s_nop 0
    buffer_load_dwordx4 v2, s[32:35], s50 offen nt lds
    s_waitcnt vmcnt(1)
    s_movk_i32 s50, 8960
    s_add_u32 m0, s52, 21504
    s_nop 0
    buffer_load_dwordx4 v2, s[32:35], s50 offen nt lds
    s_waitcnt vmcnt(1)
    s_movk_i32 s50, 7936
    s_add_u32 m0, s52, 22528
    s_nop 0
    buffer_load_dwordx4 v2, s[32:35], s50 offen nt lds
    s_waitcnt vmcnt(1)
    s_movk_i32 s50, 9088
    s_add_u32 m0, s52, 23552
    s_nop 0
    buffer_load_dwordx4 v2, s[32:35], s50 offen nt lds
    s_add_u32 s60, s60, 0x9e3779b9
    s_mul_i32 s50, s2, 3072
    s_add_u32 s40, s18, s50
    s_addc_u32 s41, s19, 0
    s_and_b32 s41, s41, 0xffff
    s_mov_b32 s42, 3072
    s_mov_b32 s43, 0x20000
    v_bfe_u32 v8, v1, 2, 2
    v_lshlrev_b32 v58, 6, v8
    v_lshrrev_b32 v8, 4, v1
    v_lshl_add_u32 v58, v8, 4, v58
    v_and_b32 v9, 1, v1
    v_lshl_add_u32 v58, v9, 3, v58
    s_lshl_b32 s50, s61, 8
    s_add_u32 s50, s50, 141312
    v_add_u32 v58, s50, v58
    v_lshlrev_b32 v59, 4, v1
    v_add_u32 v59, s52, v59
    v_and_b32 v9, 15, v1
    v_lshlrev_b32 v60, 5, v9
    v_lshl_add_u32 v60, v8, 3, v60
    s_mul_i32 s50, s61, 2560
    s_add_u32 s50, s50, 131072
    v_add_u32 v60, s50, v60
    s_mul_i32 s50, s61, 48
    v_add_u32 v9, s50, v1
    v_lshlrev_b32 v3, 4, v9
    v_lshlrev_b32 v61, 3, v9
    v_add_u32 v61, 131072, v61
    v_lshlrev_b32 v63, 2, v9
    v_add_u32 v63, 132608, v63
    v_bfe_u32 v62, v1, 1, 2
    v_xor_b32 v9, 1, v62
    v_lshl_add_u32 v62, v9, 2, v62
    v_mul_u32_u24 v62, 0x1111, v62
    s_waitcnt vmcnt(0)
    s_cmp_lg_u32 s61, 3
    s_cbranch_scc1 L_noctl
    s_add_u32 s63, s63, 0x9e3779b9
    s_and_b32 s24, s2, 7
    s_lshr_b32 s25, s2, 3
    s_mul_i32 s26, s24, 4352
    s_add_u32 s26, s26, 851968
    v_min_u32 v48, 32, v1
    v_lshlrev_b32 v48, 2, v48
    v_add_u32 v48, s26, v48
    s_lshl_b32 s50, s25, 2
    s_add_u32 s50, s50, s26
    v_mov_b32 v49, s50
    v_mov_b32 v50, 145984
    s_add_u32 s50, s26, 128
    v_mov_b32 v54, s50
    s_mul_i32 s50, s24, 4224
    s_add_u32 s50, s50, 917504
    v_mov_b32 v55, s50
    s_mov_b32 s27, 29
    s_mov_b32 s28, 1
L_ctl:
    s_sleep 1
    ds_read_b128 v[4:7], v50 offset:16
    s_waitcnt lgkmcnt(0)
    v_max3_u32 v51, v4, v5, v6
    v_max_u32 v51, v51, v7
    s_sub_u32 s30, s63, s27
    v_readfirstlane_b32 s50, v51
    s_cmp_gt_u32 s50, s27
    s_cbranch_scc1 L_ctl
    v_mov_b32 v52, s30
    s_mov_b64 exec, 1
    global_store_dword v49, v52, s[18:19]
    s_mov_b64 exec, -1
    global_load_dword v53, v48, s[18:19] sc1
    s_waitcnt vmcnt(0)
    v_readlane_b32 s36, v53, 32
    v_subrev_u32 v53, s30, v53
    v_cmp_gt_u32 vcc, 32, v53
    s_sub_u32 s36, s36, s63
    s_cmp_lt_u32 s36, 17
    s_cselect_b32 s36, s36, 9
    s_mul_i32 s36, s36, 3
    s_bcnt1_i32_b32 s31, vcc_lo
    s_lshl_b32 s37, s31, 1
    s_add_u32 s37, s37, s36
    s_mov_b32 s38, 0
    s_cmp_ge_u32 s37, 45
    s_cselect_b32 s38, 1, s38
    s_cmp_ge_u32 s37, 81
    s_cselect_b32 s38, 2, s38
    v_mov_b32 v51, s38
    ds_write_b32 v50, v51
    s_xor_b32 s28, s28, 1
    s_cbranch_scc1 L_ctlnext
    s_sub_u32 s50, s31, 7
    s_cmp_ge_u32 s50, 2
    s_cbranch_scc1 L_ctlnext
    s_mov_b64 exec, 1
    global_store_dword v55, v52, s[18:19] sc1
    s_load_dword s20, s[18:19], 917504 glc
    s_load_dword s21, s[18:19], 921728 glc
    s_load_dword s22, s[18:19], 925952 glc
    s_load_dword s23, s[18:19], 930176 glc
    s_load_dword s44, s[18:19], 934400 glc
    s_load_dword s45, s[18:19], 938624 glc
    s_load_dword s46, s[18:19], 942848 glc
    s_load_dword s47, s[18:19], 947072 glc
    s_lshl_b32 s50, 1, s24
    s_waitcnt lgkmcnt(0)
    s_sub_u32 s20, s20, s30
    s_cmp_lt_u32 s20, 32
    s_cselect_b32 s20, 1, 0
    s_or_b32 s50, s50, s20
    s_sub_u32 s21, s21, s30
    s_cmp_lt_u32 s21, 32
    s_cselect_b32 s21, 2, 0
    s_or_b32 s50, s50, s21
    s_sub_u32 s22, s22, s30
    s_cmp_lt_u32 s22, 32
    s_cselect_b32 s22, 4, 0
    s_or_b32 s50, s50, s22
    s_sub_u32 s23, s23, s30
    s_cmp_lt_u32 s23, 32
    s_cselect_b32 s23, 8, 0
    s_or_b32 s50, s50, s23
    s_sub_u32 s44, s44, s30
    s_cmp_lt_u32 s44, 32
    s_cselect_b32 s44, 16, 0
    s_or_b32 s50, s50, s44
    s_sub_u32 s45, s45, s30
    s_cmp_lt_u32 s45, 32
    s_cselect_b32 s45, 32, 0
    s_or_b32 s50, s50, s45
    s_sub_u32 s46, s46, s30
    s_cmp_lt_u32 s46, 32
    s_cselect_b32 s46, 64, 0
    s_or_b32 s50, s50, s46
    s_sub_u32 s47, s47, s30
    s_cmp_lt_u32 s47, 32
    s_cselect_b32 s47, 128, 0
    s_or_b32 s50, s50, s47
    s_bcnt1_i32_b32 s50, s50
    s_lshl_b32 s50, s50, 1
    s_add_u32 s50, s50, s63
    v_mov_b32 v53, s50
    global_store_dword v54, v53, s[18:19]
    s_mov_b64 exec, -1
L_ctlnext:
    s_sub_u32 s27, s27, 2
    s_cmp_gt_i32 s27, 1
    s_cbranch_scc1 L_ctl
    s_waitcnt vmcnt(0) lgkmcnt(0)
L_noctl:
    v_mov_b32 v4, 0
    v_mov_b32 v5, 0
    v_mov_b32 v6, 0
    v_mov_b32 v7, 0
    v_mov_b32 v8, 0
    v_mov_b32 v9, 0
    v_mov_b32 v10, 0
    v_mov_b32 v11, 0
    v_mov_b32 v12, 0
    v_mov_b32 v13, 0
    v_mov_b32 v14, 0
    v_mov_b32 v15, 0
    v_mov_b32 v16, 0
    v_mov_b32 v17, 0
    v_mov_b32 v18, 0
    v_mov_b32 v19, 0
    v_mov_b32 v20, 0
    v_mov_b32 v21, 0
    v_mov_b32 v22, 0
    v_mov_b32 v23, 0
    v_mov_b32 v24, 0
    v_mov_b32 v25, 0
    v_mov_b32 v26, 0
    v_mov_b32 v27, 0
    v_mov_b32 v28, 0
    v_mov_b32 v29, 0
    v_mov_b32 v30, 0
    v_mov_b32 v31, 0
    v_mov_b32 v32, 0
    v_mov_b32 v33, 0
    v_mov_b32 v34, 0
    v_mov_b32 v35, 0
    v_mov_b32 v36, 0
    v_mov_b32 v37, 0
    v_mov_b32 v38, 0
    v_mov_b32 v39, 0
    v_mov_b32 v40, 0
    v_mov_b32 v41, 0
    v_mov_b32 v42, 0
    v_mov_b32 v43, 0
    v_mov_b32 v44, 0
    v_mov_b32 v45, 0
    v_mov_b32 v46, 0
    v_mov_b32 v47, 0
    s_setprio 3
    s_barrier
    s_barrier
    ds_read_b64 v[48:49], v58 offset:0
    ds_read_b64 v[50:51], v58 offset:1024
    ds_read_b64 v[52:53], v58 offset:2048
    ds_read_b64 v[54:55], v58 offset:3072
    s_waitcnt lgkmcnt(2)
    v_pk_add_f32 v[48:49], v[48:49], v[50:51]
    s_waitcnt lgkmcnt(0)
    v_pk_add_f32 v[52:53], v[52:53], v[54:55]
    v_pk_add_f32 v[48:49], v[48:49], v[52:53]
    v_cvt_pk_bf16_f32 v56, v48, 0
    v_cvt_pk_bf16_f32 v57, v49, 0
    s_nop 0
    v_mov_b32_dpp v4, v56 quad_perm:[0,1,2,3] row_mask:0xf bank_mask:0x1
    v_mov_b32_dpp v5, v56 row_ror:8 row_mask:0xf bank_mask:0x4
    v_mov_b32_dpp v6, v57 quad_perm:[0,1,2,3] row_mask:0xf bank_mask:0x1
    v_mov_b32_dpp v7, v57 row_ror:8 row_mask:0xf bank_mask:0x4
    v_mov_b32_dpp v4, v56 row_ror:4 row_mask:0xf bank_mask:0x2
    v_mov_b32_dpp v5, v56 row_ror:12 row_mask:0xf bank_mask:0x8
    v_mov_b32_dpp v6, v57 row_ror:4 row_mask:0xf bank_mask:0x2
    v_mov_b32_dpp v7, v57 row_ror:12 row_mask:0xf bank_mask:0x8
    s_nop 1
    v_smfmac_f32_16x16x64_bf16 v[12:15], v[4:7], v[64:71], v62
    v_smfmac_f32_16x16x64_bf16 v[16:19], v[4:7], v[72:79], v62
    ds_read_b128 v[64:67], v59 offset:0
    v_mov_b32_dpp v8, v56 row_ror:12 row_mask:0xf bank_mask:0x1
    v_mov_b32_dpp v9, v56 row_ror:4 row_mask:0xf bank_mask:0x4
    v_smfmac_f32_16x16x64_bf16 v[20:23], v[4:7], v[80:87], v62
    ds_read_b128 v[68:71], v59 offset:1024
    v_mov_b32_dpp v10, v57 row_ror:12 row_mask:0xf bank_mask:0x1
    v_mov_b32_dpp v11, v57 row_ror:4 row_mask:0xf bank_mask:0x4
    v_smfmac_f32_16x16x64_bf16 v[24:27], v[4:7], v[88:95], v62
    ds_read_b128 v[72:75], v59 offset:2048
    v_mov_b32_dpp v8, v56 quad_perm:[0,1,2,3] row_mask:0xf bank_mask:0x2
    v_smfmac_f32_16x16x64_bf16 v[28:31], v[4:7], v[96:103], v62
    ds_read_b128 v[76:79], v59 offset:3072
    v_mov_b32_dpp v9, v56 row_ror:8 row_mask:0xf bank_mask:0x8
    v_smfmac_f32_16x16x64_bf16 v[32:35], v[4:7], v[104:111], v62
    ds_read_b128 v[80:83], v59 offset:4096
    v_mov_b32_dpp v10, v57 quad_perm:[0,1,2,3] row_mask:0xf bank_mask:0x2
    v_smfmac_f32_16x16x64_bf16 v[36:39], v[4:7], v[112:119], v62
    ds_read_b128 v[84:87], v59 offset:5120
    v_mov_b32_dpp v11, v57 row_ror:8 row_mask:0xf bank_mask:0x8
    v_smfmac_f32_16x16x64_bf16 v[40:43], v[4:7], v[120:127], v62
    ds_read_b128 v[88:91], v59 offset:6144
    v_smfmac_f32_16x16x64_bf16 v[44:47], v[4:7], v[128:135], v62
    ds_read_b128 v[92:95], v59 offset:7168
    v_smfmac_f32_16x16x64_bf16 v[12:15], v[8:11], v[136:143], v62
    ds_read_b128 v[96:99], v59 offset:8192
    v_smfmac_f32_16x16x64_bf16 v[16:19], v[8:11], v[144:151], v62
    ds_read_b128 v[100:103], v59 offset:9216
    v_mov_b32_dpp v4, v56 row_ror:8 row_mask:0xf bank_mask:0x1
    v_mov_b32_dpp v5, v56 quad_perm:[0,1,2,3] row_mask:0xf bank_mask:0x4
    v_smfmac_f32_16x16x64_bf16 v[20:23], v[8:11], v[152:159], v62
    ds_read_b128 v[104:107], v59 offset:10240
    v_mov_b32_dpp v6, v57 row_ror:8 row_mask:0xf bank_mask:0x1
    v_mov_b32_dpp v7, v57 quad_perm:[0,1,2,3] row_mask:0xf bank_mask:0x4
    v_smfmac_f32_16x16x64_bf16 v[24:27], v[8:11], v[160:167], v62
    ds_read_b128 v[108:111], v59 offset:11264
    v_mov_b32_dpp v4, v56 row_ror:12 row_mask:0xf bank_mask:0x2
    v_smfmac_f32_16x16x64_bf16 v[28:31], v[8:11], v[168:175], v62
    ds_read_b128 v[112:115], v59 offset:12288
    v_mov_b32_dpp v5, v56 row_ror:4 row_mask:0xf bank_mask:0x8
    v_smfmac_f32_16x16x64_bf16 v[32:35], v[8:11], v[176:183], v62
    ds_read_b128 v[116:119], v59 offset:13312
    v_mov_b32_dpp v6, v57 row_ror:12 row_mask:0xf bank_mask:0x2
    v_smfmac_f32_16x16x64_bf16 v[36:39], v[8:11], v[184:191], v62
    ds_read_b128 v[120:123], v59 offset:14336
    v_mov_b32_dpp v7, v57 row_ror:4 row_mask:0xf bank_mask:0x8
    v_smfmac_f32_16x16x64_bf16 v[40:43], v[8:11], v[192:199], v62
    ds_read_b128 v[124:127], v59 offset:15360
    v_smfmac_f32_16x16x64_bf16 v[44:47], v[8:11], v[200:207], v62
    ds_read_b128 v[128:131], v59 offset:16384
    v_smfmac_f32_16x16x64_bf16 v[12:15], v[4:7], v[208:215], v62
    ds_read_b128 v[132:135], v59 offset:17408
    v_smfmac_f32_16x16x64_bf16 v[16:19], v[4:7], v[216:223], v62
    ds_read_b128 v[136:139], v59 offset:18432
    v_mov_b32_dpp v8, v56 row_ror:4 row_mask:0xf bank_mask:0x1
    v_mov_b32_dpp v9, v56 row_ror:12 row_mask:0xf bank_mask:0x4
    v_smfmac_f32_16x16x64_bf16 v[20:23], v[4:7], v[224:231], v62
    ds_read_b128 v[140:143], v59 offset:19456
    v_mov_b32_dpp v10, v57 row_ror:4 row_mask:0xf bank_mask:0x1
    v_mov_b32_dpp v11, v57 row_ror:12 row_mask:0xf bank_mask:0x4
    v_smfmac_f32_16x16x64_bf16 v[24:27], v[4:7], v[232:239], v62
    ds_read_b128 v[144:147], v59 offset:20480
    v_mov_b32_dpp v8, v56 row_ror:8 row_mask:0xf bank_mask:0x2
    v_smfmac_f32_16x16x64_bf16 v[28:31], v[4:7], v[240:247], v62
    ds_read_b128 v[148:151], v59 offset:21504
    v_mov_b32_dpp v9, v56 quad_perm:[0,1,2,3] row_mask:0xf bank_mask:0x8
    v_smfmac_f32_16x16x64_bf16 v[32:35], v[4:7], v[248:255], v62
    ds_read_b128 v[152:155], v59 offset:22528
    v_mov_b32_dpp v10, v57 row_ror:8 row_mask:0xf bank_mask:0x2
    s_waitcnt lgkmcnt(14)
    v_smfmac_f32_16x16x64_bf16 v[36:39], v[4:7], v[64:71], v62
    ds_read_b128 v[156:159], v59 offset:23552
    v_mov_b32_dpp v11, v57 quad_perm:[0,1,2,3] row_mask:0xf bank_mask:0x8
    s_waitcnt lgkmcnt(14)
    v_smfmac_f32_16x16x64_bf16 v[40:43], v[4:7], v[72:79], v62
    s_waitcnt lgkmcnt(14)
    v_smfmac_f32_16x16x64_bf16 v[44:47], v[4:7], v[80:87], v62
    s_waitcnt lgkmcnt(14)
    v_smfmac_f32_16x16x64_bf16 v[12:15], v[8:11], v[88:95], v62
    s_waitcnt lgkmcnt(14)
    v_smfmac_f32_16x16x64_bf16 v[16:19], v[8:11], v[96:103], v62
    s_waitcnt lgkmcnt(12)
    v_smfmac_f32_16x16x64_bf16 v[20:23], v[8:11], v[104:111], v62
    s_waitcnt lgkmcnt(10)
    v_smfmac_f32_16x16x64_bf16 v[24:27], v[8:11], v[112:119], v62
    s_waitcnt lgkmcnt(0)
    v_smfmac_f32_16x16x64_bf16 v[28:31], v[8:11], v[120:127], v62
    v_add_f32_dpp v184, v13, v12 row_ror:8 row_mask:0xf bank_mask:0x3
    v_add_f32_dpp v185, v15, v14 row_ror:8 row_mask:0xf bank_mask:0x3
    v_smfmac_f32_16x16x64_bf16 v[32:35], v[8:11], v[128:135], v62
    v_add_f32_dpp v184, v16, v17 row_ror:8 row_mask:0xf bank_mask:0xc
    v_add_f32_dpp v185, v18, v19 row_ror:8 row_mask:0xf bank_mask:0xc
    ds_write_b64 v60, v[184:185] offset:0
    v_smfmac_f32_16x16x64_bf16 v[36:39], v[8:11], v[136:143], v62
    v_add_f32_dpp v186, v21, v20 row_ror:8 row_mask:0xf bank_mask:0x3
    v_add_f32_dpp v187, v23, v22 row_ror:8 row_mask:0xf bank_mask:0x3
    v_smfmac_f32_16x16x64_bf16 v[40:43], v[8:11], v[144:151], v62
    v_add_f32_dpp v186, v24, v25 row_ror:8 row_mask:0xf bank_mask:0xc
    v_add_f32_dpp v187, v26, v27 row_ror:8 row_mask:0xf bank_mask:0xc
    ds_write_b64 v60, v[186:187] offset:512
    v_smfmac_f32_16x16x64_bf16 v[44:47], v[8:11], v[152:159], v62
    v_add_f32_dpp v188, v29, v28 row_ror:8 row_mask:0xf bank_mask:0x3
    v_add_f32_dpp v189, v31, v30 row_ror:8 row_mask:0xf bank_mask:0x3
    s_nop 0
    v_add_f32_dpp v188, v32, v33 row_ror:8 row_mask:0xf bank_mask:0xc
    v_add_f32_dpp v189, v34, v35 row_ror:8 row_mask:0xf bank_mask:0xc
    ds_write_b64 v60, v[188:189] offset:1024
    v_add_f32_dpp v190, v37, v36 row_ror:8 row_mask:0xf bank_mask:0x3
    v_add_f32_dpp v191, v39, v38 row_ror:8 row_mask:0xf bank_mask:0x3
    s_nop 0
    v_add_f32_dpp v190, v40, v41 row_ror:8 row_mask:0xf bank_mask:0xc
    v_add_f32_dpp v191, v42, v43 row_ror:8 row_mask:0xf bank_mask:0xc
    ds_write_b64 v60, v[190:191] offset:1536
    v_add_f32_dpp v192, v45, v44 row_ror:8 row_mask:0xf bank_mask:0x3
    v_add_f32_dpp v193, v47, v46 row_ror:8 row_mask:0xf bank_mask:0x3
    ds_write_b64 v60, v[192:193] offset:2048
    s_mov_b32 exec_hi, 0xffff
    v_mov_b32 v51, s60
    s_waitcnt lgkmcnt(0)
    s_barrier
    ds_read_b64 v[12:13], v61 offset:0
    ds_read_b32 v14, v63 offset:0
    ds_read_b64 v[16:17], v61 offset:2560
    ds_read_b32 v18, v63 offset:2560
    ds_read_b64 v[20:21], v61 offset:5120
    ds_read_b32 v22, v63 offset:5120
    ds_read_b64 v[24:25], v61 offset:7680
    ds_read_b32 v26, v63 offset:7680
    s_waitcnt lgkmcnt(4)
    v_pk_add_f32 v[12:13], v[12:13], v[16:17]
    v_add_f32 v14, v14, v18
    s_waitcnt lgkmcnt(0)
    v_pk_add_f32 v[20:21], v[20:21], v[24:25]
    v_add_f32 v22, v22, v26
    v_pk_add_f32 v[48:49], v[12:13], v[20:21]
    v_add_f32 v50, v14, v22
    buffer_store_dwordx4 v[48:51], v3, s[40:43], 0 offen sc1
L_end:
    s_endpgm
.section .rodata,"a"
.p2align 6
.amdhsa_kernel standalone__gqa_block_cached__sampling_kernel
  .amdhsa_next_free_vgpr 256
  .amdhsa_next_free_sgpr 96
  .amdhsa_accum_offset 256
  .amdhsa_group_segment_fixed_size 0
  .amdhsa_kernarg_size 64
  .amdhsa_user_sgpr_count 2
  .amdhsa_user_sgpr_kernarg_segment_ptr 1
  .amdhsa_system_sgpr_workgroup_id_x 1
.end_amdhsa_kernel
```
